```python
import torch

def _softmax(x, axis=-1):
    return torch.softmax(x, dim=axis)
def _gelu(x):
    return torch.nn.functional.gelu(x, approximate="tanh")
def _silu(x):
    return torch.nn.functional.silu(x)
def _sigmoid(x):
    return torch.sigmoid(x)
def _layernorm(x, axis=-1, eps=1e-5):
    m = x.mean(dim=axis, keepdim=True)
    v = x.var(dim=axis, keepdim=True, unbiased=False)
    return (x - m) / torch.sqrt(v + eps)
def _scatter_add(tgt, idx, src, axis=0):
    return tgt.clone().index_add_(axis, idx, src)
def _segment_sum(src, seg, n):
    out = torch.zeros((n,) + src.shape[1:], dtype=src.dtype)
    return out.index_add_(0, seg, src)
def _pad(x, pw):
    flat = tuple(v for pair in reversed(pw) for v in pair)
    return torch.nn.functional.pad(x, flat)

kernel_name = 'gated_mix__sliding_local_dilated__sliding_local_dilated__prompt'

def setup_inputs():

    _w = (lambda a: (lambda t: t.to(torch.bfloat16) if t.is_floating_point() else t)(torch.as_tensor(a)))
    def _A_setup():
        B, S, D = 1, 2048, 640
        return {
            "x": _w((lambda *s: torch.randn(*s, dtype=torch.bfloat16) * 0.05)(B, S, D)),
            "wqkv": _w((lambda *s: torch.randn(*s, dtype=torch.bfloat16) * 0.8)(D, 3 * D)),
            "wo": _w((lambda *s: torch.randn(*s, dtype=torch.bfloat16) * 0.05)(D, D)),
        }
    _A_in = _A_setup()

    def _B_setup():
        B, S, D = 1, 2048, 640
        return {
            "x": _w((lambda *s: torch.randn(*s, dtype=torch.bfloat16) * 0.05)(B, S, D)),
            "wqkv": _w((lambda *s: torch.randn(*s, dtype=torch.bfloat16) * 0.8)(D, 3 * D)),
            "wo": _w((lambda *s: torch.randn(*s, dtype=torch.bfloat16) * 0.05)(D, D)),
        }
    _B_in = _B_setup()

    return {
        "A_x": _A_in["x"],
        "A_wqkv": _A_in["wqkv"],
        "A_wo": _A_in["wo"],
        "B_x": _B_in["x"],
        "B_wqkv": _B_in["wqkv"],
        "B_wo": _B_in["wo"],
        "gate_w": _w((lambda *s: torch.randn(*s, dtype=torch.bfloat16) * 0.05)(640) * 16.0),
    }

def reference(A_x, A_wqkv, A_wo, B_x, B_wqkv, B_wo, gate_w):
    def _A_ref(x, wqkv, wo):
        B, S, D = x.shape
        H = 32; Dh = D // H
        W, dil = 8, 2
        qkv = (lambda x, *d: x.permute(*d))((x @ wqkv).reshape(B, S, 3, H, Dh), 2, 0, 3, 1, 4)
        q, k, v = qkv[0], qkv[1], qkv[2]
        scale = Dh ** -0.5
        pos = torch.arange(S)
        off = torch.arange(W) * dil
        idx = pos[:, None] - off[None, :]
        mask = idx >= 0
        idx_c = torch.where(mask, idx, 0).reshape(-1)
        kg = k[:, :, idx_c, :].reshape(B, H, S, W, Dh)
        vg = v[:, :, idx_c, :].reshape(B, H, S, W, Dh)
        logits = torch.einsum("bhsd,bhswd->bhsw", q, kg) * scale
        logits = torch.where(mask[None, None, :, :], logits, -1e9)
        attn = _softmax(logits, axis=-1)
        o = torch.einsum("bhsw,bhswd->bhsd", attn, vg)
        return (lambda x, *d: x.permute(*d))(o, 0, 2, 1, 3).reshape(B, S, D) @ wo

    def _B_ref(x, wqkv, wo):
        B, S, D = x.shape
        H = 32; Dh = D // H
        W, dil = 8, 2
        qkv = (lambda x, *d: x.permute(*d))((x @ wqkv).reshape(B, S, 3, H, Dh), 2, 0, 3, 1, 4)
        q, k, v = qkv[0], qkv[1], qkv[2]
        scale = Dh ** -0.5
        pos = torch.arange(S)
        off = torch.arange(W) * dil
        idx = pos[:, None] - off[None, :]
        mask = idx >= 0
        idx_c = torch.where(mask, idx, 0).reshape(-1)
        kg = k[:, :, idx_c, :].reshape(B, H, S, W, Dh)
        vg = v[:, :, idx_c, :].reshape(B, H, S, W, Dh)
        logits = torch.einsum("bhsd,bhswd->bhsw", q, kg) * scale
        logits = torch.where(mask[None, None, :, :], logits, -1e9)
        attn = _softmax(logits, axis=-1)
        o = torch.einsum("bhsw,bhswd->bhsd", attn, vg)
        return (lambda x, *d: x.permute(*d))(o, 0, 2, 1, 3).reshape(B, S, D) @ wo

    x = A_x
    g = _sigmoid((x * gate_w).sum(-1, keepdims=True))
    a = _A_ref(x, A_wqkv, A_wo)
    b = _B_ref(x, B_wqkv, B_wo)
    return g * a + (1 - g) * b
```

```asm
; @launch grid=(256,1,1) block=(512,1,1) lds=163840
.amdgcn_target "amdgcn-amd-amdhsa--gfx950"
.text
.globl gated_mix__sliding_local_dilated__sliding_local_dilated__prompt_kernel
.p2align 8
.type gated_mix__sliding_local_dilated__sliding_local_dilated__prompt_kernel,@function
gated_mix__sliding_local_dilated__sliding_local_dilated__prompt_kernel:
v_readfirstlane_b32 s22, v0
s_load_dwordx8 s[4:11], s[0:1], 0
s_load_dwordx8 s[12:19], s[0:1], 32
s_lshr_b32 s3, s2, 8
s_cbranch_scc1 L_END
s_lshr_b32 s22, s22, 6
s_cmp_eq_u32 s22, 3
s_cbranch_scc1 L_HOP
s_cmp_lt_u32 s22, 4
s_cbranch_scc1 L_COMPUTE
v_and_b32 v1, 63, v0
s_lshr_b32 s44, s2, 3
s_cmp_lg_u32 s22, 6
s_cbranch_scc1 L_E0
s_getpc_b64 s[70:71]
L_PC0:
s_mul_i32 s45, s44, 6
v_min_u32 v3, 5, v1
v_add_lshl_u32 v3, v3, s45, 7
v_min_u32 v3, CODE_END - L_PC0 - 4, v3
global_load_dword v41, v3, s[70:71]
L_E0:
v_mul_u32_u24 v3, 13108, v1
v_lshrrev_b32 v3, 16, v3
v_mul_u32_u24 v3, 640, v3
v_lshlrev_b32 v4, 7, v1
v_add_u32 v40, v4, v3
v_lshrrev_b32 v3, 1, v1
v_lshl_add_u32 v42, v3, 10, v4
s_mul_i32 s92, s44, 24
s_and_b32 s45, s2, 1
s_add_u32 s92, s92, s45
s_mulk_i32 s92, 640
s_and_b32 s45, s2, 4
s_lshl_b32 s45, s45, 3
s_add_u32 s44, s44, s45
s_mul_i32 s93, s44, 40960
s_mov_b32 s26, 2457600
s_mov_b32 s30, 2621440
s_mov_b32 s31, 0x20000
s_mov_b32 s27, s31
s_bitcmp1_b32 s2, 1
s_waitcnt lgkmcnt(0)
s_cselect_b64 s[24:25], s[12:13], s[6:7]
s_mov_b64 s[28:29], s[4:5]
s_cmp_lg_u32 s22, 4
s_cbranch_scc1 L_E1
buffer_load_dword v41, v42, s[28:31], s93 offen
L_E1:
s_cmp_lg_u32 s22, 5
s_cbranch_scc1 L_LD0
buffer_load_dword v41, v40, s[24:27], s92 offen
s_branch L_LD0
.p2align 8
L_HOP:
s_branch L_COMPUTE
L_LD0:
s_setprio 2
s_cmp_lg_u32 s22, 7
s_cbranch_scc1 L_NGW
s_mov_b32 s36, s16
s_mov_b32 s37, s17
s_mov_b32 s38, 1280
s_mov_b32 s39, 0x20000
s_mov_b32 m0, 147456
v_lshlrev_b32 v12, 4, v1
buffer_load_dwordx4 v12, s[36:39], 0 offen lds
buffer_load_dwordx4 v12, s[36:39], 0 offen offset:1024 lds
L_NGW:
v_and_b32 v1, 63, v0
s_and_b32 s20, s2, 3
s_lshl_b32 s20, s20, 2
s_bfe_u32 s46, s2, 0x20003
s_add_u32 s20, s20, s46
s_lshr_b32 s47, s2, 5
s_and_b32 s21, s2, 4
s_lshl_b32 s21, s21, 1
s_add_u32 s21, s21, s47
v_lshrrev_b32 v3, 3, v1
v_mul_u32_u24 v3, 2560, v3
v_lshrrev_b32 v4, 4, v0
v_xor_b32 v4, v4, v1
v_xor_b32 v4, 4, v4
v_and_b32 v4, 7, v4
v_lshl_add_u32 v11, v4, 4, v3
s_and_b32 s64, s22, 3
s_lshr_b32 s44, s21, 1
s_or_b32 s45, s44, s64
s_cselect_b32 s52, -20480, 0
s_lshl_b32 s44, s44, 8
s_and_b32 s45, s21, 1
s_add_u32 s44, s44, s45
s_lshl_b32 s45, s64, 4
s_add_u32 s44, s44, s45
s_mul_i32 s47, s44, 1280
s_lshl_b32 s53, s64, 10
v_mul_u32_u24 v3, 6554, v1
v_lshrrev_b32 v3, 16, v3
v_mul_u32_u24 v4, 1120, v3
v_lshl_add_u32 v10, v1, 4, v4
s_and_b32 s46, s20, 7
s_mul_i32 s46, s46, 160
s_mul_i32 s44, s64, 61440
s_add_u32 s46, s46, s44
s_mul_i32 s48, s64, 7680
s_mov_b32 s49, 0
s_mov_b32 s50, 0
s_mov_b32 s87, 0
s_mov_b32 s86, 15
s_load_dwordx4 s[76:79], s[0:1], 64
L_LD_ISSUE:
s_add_u32 m0, s53, 31744
s_add_u32 s51, s47, s52
buffer_load_dwordx4 v11, s[28:31], s51 offen lds
s_add_u32 m0, s53, 35840
s_add_u32 s51, s47, 61440
buffer_load_dwordx4 v11, s[28:31], s51 offen lds
s_add_u32 m0, s53, 39936
s_add_u32 s51, s47, 143360
buffer_load_dwordx4 v11, s[28:31], s51 offen lds
s_add_u32 m0, s53, 44032
s_add_u32 s51, s47, 225280
buffer_load_dwordx4 v11, s[28:31], s51 offen lds
s_mov_b32 exec_hi, 0x0fffffff
s_add_u32 m0, s48, 0
s_add_u32 s51, s46, 0
buffer_load_dwordx4 v10, s[24:27], s51 offen lds
s_add_u32 m0, s48, 960
s_add_u32 s51, s46, 7680
buffer_load_dwordx4 v10, s[24:27], s51 offen lds
s_add_u32 m0, s48, 1920
s_add_u32 s51, s46, 30720
buffer_load_dwordx4 v10, s[24:27], s51 offen lds
s_add_u32 m0, s48, 2880
s_add_u32 s51, s46, 38400
buffer_load_dwordx4 v10, s[24:27], s51 offen lds
s_add_u32 m0, s48, 3840
s_add_u32 s51, s46, 15360
buffer_load_dwordx4 v10, s[24:27], s51 offen lds
s_cmp_eq_u32 s86, 5
s_cbranch_scc1 L_HK5
L_HR5:
s_add_u32 m0, s48, 4800
s_add_u32 s51, s46, 23040
buffer_load_dwordx4 v10, s[24:27], s51 offen lds
s_add_u32 m0, s48, 5760
s_add_u32 s51, s46, 46080
buffer_load_dwordx4 v10, s[24:27], s51 offen lds
s_add_u32 m0, s48, 6720
s_add_u32 s51, s46, 53760
buffer_load_dwordx4 v10, s[24:27], s51 offen lds
s_mov_b32 exec_hi, -1
s_cmp_lg_u32 s64, 0
s_cbranch_scc1 L_LD_W
s_add_u32 m0, s53, 48128
s_add_u32 s51, s47, 307200
buffer_load_dwordx4 v11, s[28:31], s51 offen lds
L_LD_W:
s_mov_b32 s63, 49152
s_add_u32 s46, s46, 245760
s_add_u32 s47, s47, 128
s_add_u32 s49, s49, 1
s_cmp_eq_u32 s49, 3
s_cselect_b32 s51, 4294868992, s63
s_cselect_b32 s49, 0, s49
s_add_u32 s48, s48, s51
s_add_u32 s53, s53, s51
s_add_u32 s50, s50, 1
s_cmp_lt_u32 s50, 2
s_cbranch_scc1 L_LD_PRE0
L_DISP:
s_cmp_eq_u32 s50, s96
s_cbranch_scc1 L_SIDE_A
L_SA_RET:
s_cmp_eq_u32 s50, s97
s_cbranch_scc1 L_TOK_A
s_cmp_eq_u32 s50, s98
s_cbranch_scc1 L_TOK_B
s_cmp_eq_u32 s50, 9
s_cbranch_scc1 L_WOF_A
s_cmp_eq_u32 s50, 10
s_cbranch_scc1 L_WOF_B
L_LD_WAIT:
L_LD_BAR:
L_LD_PRE:
s_bitcmp1_b32 s94, s50
s_cbranch_scc0 L_LD_TOP
s_add_u32 s87, s87, 2
s_waitcnt vmcnt(6)
s_cmp_eq_u32 s64, 0
s_cbranch_scc1 L_PFX
buffer_load_dword v41, v40, s[24:27], s92 offen
s_add_u32 s92, s92, 15360
buffer_load_dword v41, v40, s[24:27], s92 offen
s_add_u32 s92, s92, 967680
s_branch L_LD_TOP
L_PFX:
buffer_load_dword v41, v42, s[28:31], s93 offen
s_add_u32 s93, s93, 40960
buffer_load_dword v41, v42, s[28:31], s93 offen
s_add_u32 s93, s93, 4294926848
s_branch L_LD_TOP
L_LD_TOP:
s_and_b32 s86, s100, 15
s_lshr_b64 s[100:101], s[100:101], 4
s_cmp_lg_u32 s86, 10
s_cbranch_scc1 L_LD_ISSUE
s_cmp_eq_u32 s87, 1
s_cbranch_scc1 L_HA_1
s_cmp_eq_u32 s87, 2
s_cbranch_scc1 L_HA_2
s_cmp_eq_u32 s87, 3
s_cbranch_scc1 L_HA_3
s_cmp_eq_u32 s87, 6
s_cbranch_scc1 L_HA_6
s_cmp_eq_u32 s87, 8
s_cbranch_scc1 L_HA_8
s_waitcnt vmcnt(0)
L_HA_B:
s_barrier
s_mov_b32 s87, 0
s_branch L_LD_ISSUE
L_HA_1:
s_waitcnt vmcnt(1)
s_branch L_HA_B
L_HA_2:
s_waitcnt vmcnt(2)
s_branch L_HA_B
L_HA_3:
s_waitcnt vmcnt(3)
s_branch L_HA_B
L_HA_6:
s_waitcnt vmcnt(6)
s_branch L_HA_B
L_HA_8:
s_waitcnt vmcnt(8)
s_branch L_HA_B
L_HK5:
s_cmp_eq_u32 s87, 1
s_cbranch_scc1 L_H5_1
s_cmp_eq_u32 s87, 2
s_cbranch_scc1 L_H5_2
s_cmp_eq_u32 s87, 3
s_cbranch_scc1 L_H5_3
s_cmp_eq_u32 s87, 6
s_cbranch_scc1 L_H5_6
s_cmp_eq_u32 s87, 8
s_cbranch_scc1 L_H5_8
s_waitcnt vmcnt(9)
L_H5_B:
s_barrier
s_mov_b32 s87, 0
s_branch L_HR5
L_H5_1:
s_waitcnt vmcnt(10)
s_branch L_H5_B
L_H5_2:
s_waitcnt vmcnt(11)
s_branch L_H5_B
L_H5_3:
s_waitcnt vmcnt(12)
s_branch L_H5_B
L_H5_6:
s_waitcnt vmcnt(15)
s_branch L_H5_B
L_H5_8:
s_waitcnt vmcnt(17)
s_branch L_H5_B
L_LD_PRE0:
v_lshlrev_b32 v12, 4, v1
v_mov_b32 v13, 0
s_bfe_u32 s45, s2, 0x10003
s_mul_i32 s44, s45, 476160
s_add_u32 s92, s92, s44
s_add_u32 s92, s92, 491520
s_mul_i32 s44, s45, 40704
s_sub_u32 s93, s93, s44
s_add_u32 s93, s93, 256
s_mov_b32 s94, 0
s_cmp_eq_u32 s45, 0
s_cselect_b32 s94, 34, s94
s_cmp_eq_u32 s45, 1
s_cselect_b32 s94, 136, s94
s_cmp_ge_u32 s64, 2
s_cselect_b32 s94, 0, s94
s_waitcnt lgkmcnt(0)
s_bitcmp1_b32 s2, 3
s_cselect_b32 s96, 2, 2
s_cselect_b32 s97, 4, 4
s_add_u32 s98, s97, 2
s_mov_b32 s100, 1431983450
s_mov_b32 s101, 5
s_bitcmp1_b32 s2, 3
s_cselect_b32 s100, 1515543125, s100
s_cselect_b32 s101, 5, s101
s_branch L_DISP
L_SIDE_A:
s_mov_b32 s56, 0
s_cmp_lt_u32 s64, 2
s_cbranch_scc1 L_SA_RET
s_mov_b32 s57, s2
s_cmp_eq_u32 s64, 2
s_cbranch_scc1 L_SA_GO
s_bitcmp0_b32 s2, 3
s_cbranch_scc1 L_SA_RET
s_lshr_b32 s44, s2, 4
s_sub_u32 s44, s44, 4
s_cmp_ge_u32 s44, 8
s_cbranch_scc1 L_SA_RET
s_lshl_b32 s44, s44, 3
s_and_b32 s57, s2, 7
s_add_u32 s57, s57, s44
s_add_u32 s57, s57, 256
L_SA_GO:
s_mov_b32 s56, 1
s_mov_b32 s39, 0x20000
s_and_b32 s45, s57, 7
s_lshr_b32 s44, s57, 3
s_mul_i32 s58, s44, 52
s_lshr_b32 s58, s58, 8
s_mul_i32 s59, s58, 5
s_sub_u32 s59, s44, s59
s_cmp_ge_u32 s58, 4
s_cselect_b32 s36, s14, s8
s_cselect_b32 s37, s15, s9
s_mov_b32 s38, 819200
s_and_b32 s58, s58, 3
s_mul_i32 s58, s58, 160
s_mul_i32 s60, s59, 40
s_cmp_eq_u32 s59, 4
s_cselect_b32 s60, 16, s60
s_cselect_b32 s54, 80, 20
s_cselect_b32 s55, 20, 4
s_add_u32 s58, s58, s60
s_mul_i32 s58, s58, 1280
s_mul_i32 s60, s45, 160
s_add_u32 s58, s58, s60
s_mul_i32 s54, s54, 1280
s_mul_i32 s55, s55, 1280
s_mul_i32 s62, s64, 5120
s_add_u32 s62, s62, 139264
s_mov_b32 exec_hi, 0xff
s_add_u32 m0, s62, 0
s_add_u32 s51, s58, s54
buffer_load_dwordx4 v10, s[36:39], s58 offen lds
s_add_u32 m0, s62, 1280
s_add_u32 s58, s58, s55
buffer_load_dwordx4 v10, s[36:39], s51 offen lds
s_add_u32 m0, s62, 640
s_add_u32 s51, s58, s54
buffer_load_dwordx4 v10, s[36:39], s58 offen lds
s_add_u32 m0, s62, 1920
s_add_u32 s58, s58, s55
buffer_load_dwordx4 v10, s[36:39], s51 offen lds
s_add_u32 m0, s62, 2560
s_add_u32 s51, s58, s54
buffer_load_dwordx4 v10, s[36:39], s58 offen lds
s_add_u32 m0, s62, 3840
s_add_u32 s58, s58, s55
buffer_load_dwordx4 v10, s[36:39], s51 offen lds
s_add_u32 m0, s62, 3200
s_add_u32 s51, s58, s54
buffer_load_dwordx4 v10, s[36:39], s58 offen lds
s_add_u32 m0, s62, 4480
s_add_u32 s58, s58, s55
buffer_load_dwordx4 v10, s[36:39], s51 offen lds
s_mov_b32 exec_hi, -1
s_mul_i32 s61, s45, 204800
s_mul_i32 s58, s44, 5120
s_add_u32 s61, s61, s58
s_add_u32 s61, s61, 5767168
s_mov_b32 s87, 8
s_branch L_LD_BAR
L_SIDE_B:
v_lshrrev_b32 v16, 5, v1
v_lshlrev_b32 v16, 4, v16
v_bfe_u32 v17, v1, 4, 1
v_lshl_add_u32 v16, v17, 2, v16
v_bfe_u32 v17, v1, 2, 2
v_add_u32 v16, v16, v17
v_mul_u32_u24 v16, 160, v16
v_add_u32 v16, s62, v16
v_and_b32 v17, 3, v1
v_lshl_add_u32 v18, v17, 4, v16
v_lshl_add_u32 v19, v17, 3, v16
ds_read_b64_tr_b16 v[20:21], v18 offset:0
ds_read_b64_tr_b16 v[22:23], v18 offset:1280
ds_read_b64_tr_b16 v[24:25], v18 offset:8
ds_read_b64_tr_b16 v[26:27], v18 offset:1288
ds_read_b64_tr_b16 v[28:29], v18 offset:64
ds_read_b64_tr_b16 v[30:31], v18 offset:1344
ds_read_b64_tr_b16 v[32:33], v18 offset:72
ds_read_b64_tr_b16 v[34:35], v18 offset:1352
ds_read_b64_tr_b16 v[36:37], v19 offset:128
ds_read_b64_tr_b16 v[38:39], v19 offset:1408
s_waitcnt lgkmcnt(0)
buffer_store_dwordx4 v[20:23], v12, s[32:35], s61 offen offset:0 sc1
buffer_store_dwordx4 v[24:27], v12, s[32:35], s61 offen offset:1024 sc1
buffer_store_dwordx4 v[28:31], v12, s[32:35], s61 offen offset:2048 sc1
buffer_store_dwordx4 v[32:35], v12, s[32:35], s61 offen offset:3072 sc1
s_add_u32 s61, s61, 4096
buffer_store_dwordx4 v[36:39], v12, s[32:35], s61 offen sc1
s_mov_b32 s87, 6
s_branch L_LD_BAR
L_TOK_A:
s_add_u32 s32, s78, 0
s_addc_u32 s33, s79, 0
s_mov_b32 s34, 268435456
s_mov_b32 s35, 0x20000
s_mov_b32 s40, s76
s_mov_b32 s41, s77
s_mov_b32 s42, 256
s_mov_b32 s43, 0x20000
v_lshlrev_b32 v12, 4, v1
v_mov_b32 v13, 0
s_mov_b64 exec, 1
buffer_load_dword v15, v13, s[40:43], 0 offen sc1
s_mov_b64 exec, -1
s_cmp_lg_u32 s56, 0
s_cbranch_scc1 L_SIDE_B
s_mov_b32 s87, 1
s_branch L_LD_BAR
L_TOK_B:
s_add_u32 s32, s78, 0
s_addc_u32 s33, s79, 0
s_mov_b32 s34, 268435456
s_mov_b32 s35, 0x20000
s_mov_b32 s40, s76
s_mov_b32 s41, s77
s_mov_b32 s42, 256
s_mov_b32 s43, 0x20000
s_mov_b32 s60, 0
v_mov_b32 v13, 0
L_TOK_CHK:
v_readlane_b32 s75, v15, 0
s_add_u32 s60, s60, 1
s_cmp_lg_u32 s75, 0
s_cbranch_scc1 L_TOK_OK
s_cmp_ge_u32 s60, 131072
s_cbranch_scc1 L_TOK_OK
s_sleep 4
s_mov_b64 exec, 1
buffer_load_dword v15, v13, s[40:43], 0 offen sc1
s_mov_b64 exec, -1
s_waitcnt vmcnt(0)
s_branch L_TOK_CHK
L_TOK_OK:
v_mov_b32 v14, 148992
v_mov_b32 v15, s75
ds_write_b32 v14, v15
s_cmp_eq_u32 s56, 0
s_waitcnt lgkmcnt(0)
s_cbranch_scc1 L_LD_WAIT
s_and_b32 s45, s57, 7
s_lshl_b32 s45, s45, 13
s_lshr_b32 s44, s57, 3
s_lshl_b32 s44, s44, 7
s_add_u32 s45, s45, s44
s_add_u32 s45, s45, 7471104
v_lshlrev_b32 v13, 2, v1
s_mov_b32 exec_hi, 0
buffer_store_dword v15, v13, s[32:35], s45 offen sc1
s_mov_b32 exec_hi, -1
s_mov_b32 s87, 1
s_branch L_LD_BAR
L_WOF_A:
s_add_u32 s32, s78, 0
s_addc_u32 s33, s79, 0
s_mov_b32 s34, 268435456
s_mov_b32 s35, 0x20000
s_mov_b32 s40, s76
s_mov_b32 s41, s77
s_mov_b32 s42, 256
s_mov_b32 s43, 0x20000
s_bfe_u32 s84, s2, 0x30003
s_and_b32 s85, s2, 7
s_lshl_b32 s85, s85, 2
s_lshr_b32 s86, s2, 6
s_add_u32 s85, s85, s86
s_lshl_b32 s59, s84, 13
s_add_u32 s59, s59, 7471104
s_lshr_b32 s44, s64, 1
s_mul_i32 s44, s44, 2560
s_add_u32 s59, s59, s44
v_lshlrev_b32 v13, 7, v1
v_lshlrev_b32 v12, 4, v1
s_mov_b64 exec, 0xfffff
buffer_load_dword v14, v13, s[32:35], s59 offen sc1
s_mov_b64 exec, -1
s_mov_b32 s87, 1
s_branch L_LD_BAR
L_WOF_B:
s_add_u32 s32, s78, 0
s_addc_u32 s33, s79, 0
s_mov_b32 s34, 268435456
s_mov_b32 s35, 0x20000
s_mov_b32 s40, s76
s_mov_b32 s41, s77
s_mov_b32 s42, 256
s_mov_b32 s43, 0x20000
v_lshlrev_b32 v12, 4, v1
v_lshlrev_b32 v13, 7, v1
s_mov_b64 exec, 0xfffff
s_mov_b32 s60, 0
s_waitcnt vmcnt(12)
L_WO_POLL:
v_cmp_ne_u32 vcc, s75, v14
s_cbranch_vccz L_WO_OK
s_add_u32 s60, s60, 1
s_cmp_ge_u32 s60, 131072
s_cbranch_scc1 L_WO_OK
s_sleep 4
buffer_load_dword v14, v13, s[32:35], s59 offen sc1
s_waitcnt vmcnt(0)
s_branch L_WO_POLL
L_WO_OK:
s_mov_b64 exec, -1
s_setprio 0
s_mul_i32 s58, s84, 204800
s_add_u32 s58, s58, 5767168
s_lshr_b32 s44, s64, 1
s_and_b32 s45, s64, 1
s_lshl_b32 s45, s45, 10
s_mul_i32 s59, s44, 102400
s_add_u32 s59, s59, s58
s_add_u32 s59, s59, s45
s_xor_b32 s54, s84, s85
s_and_b32 s54, s54, 0
s_mul_i32 s54, s54, 51200
s_sub_u32 s55, s59, s54
s_add_u32 s59, s59, s54
s_mul_i32 s53, s44, 24576
s_add_u32 s53, s53, s45
s_add_u32 m0, s53, 49152
s_add_u32 s51, s59, 0
buffer_load_dwordx4 v12, s[32:35], s51 offen sc1 lds
s_add_u32 m0, s53, 51200
s_add_u32 s51, s59, 2048
buffer_load_dwordx4 v12, s[32:35], s51 offen sc1 lds
s_add_u32 m0, s53, 53248
s_add_u32 s51, s59, 4096
buffer_load_dwordx4 v12, s[32:35], s51 offen sc1 lds
s_add_u32 m0, s53, 55296
s_add_u32 s51, s59, 6144
buffer_load_dwordx4 v12, s[32:35], s51 offen sc1 lds
s_add_u32 m0, s53, 57344
s_add_u32 s51, s59, 8192
buffer_load_dwordx4 v12, s[32:35], s51 offen sc1 lds
s_add_u32 m0, s53, 59392
s_add_u32 s51, s59, 10240
buffer_load_dwordx4 v12, s[32:35], s51 offen sc1 lds
s_waitcnt vmcnt(6)
s_barrier
s_mul_i32 s53, s44, 24576
s_add_u32 s53, s53, s45
s_add_u32 m0, s53, 61440
s_add_u32 s51, s59, 12288
buffer_load_dwordx4 v12, s[32:35], s51 offen sc1 lds
s_add_u32 m0, s53, 63488
s_add_u32 s51, s59, 14336
buffer_load_dwordx4 v12, s[32:35], s51 offen sc1 lds
s_add_u32 m0, s53, 65536
s_add_u32 s51, s59, 16384
buffer_load_dwordx4 v12, s[32:35], s51 offen sc1 lds
s_add_u32 m0, s53, 67584
s_add_u32 s51, s59, 18432
buffer_load_dwordx4 v12, s[32:35], s51 offen sc1 lds
s_add_u32 m0, s53, 69632
s_add_u32 s51, s59, 20480
buffer_load_dwordx4 v12, s[32:35], s51 offen sc1 lds
s_add_u32 m0, s53, 71680
s_add_u32 s51, s59, 22528
buffer_load_dwordx4 v12, s[32:35], s51 offen sc1 lds
s_mul_i32 s53, s44, 14336
s_add_u32 s53, s53, s45
s_add_u32 m0, s53, 98304
s_add_u32 s51, s59, 24576
buffer_load_dwordx4 v12, s[32:35], s51 offen sc1 lds
s_add_u32 m0, s53, 100352
s_add_u32 s51, s59, 26624
buffer_load_dwordx4 v12, s[32:35], s51 offen sc1 lds
s_add_u32 m0, s53, 102400
s_add_u32 s51, s59, 28672
buffer_load_dwordx4 v12, s[32:35], s51 offen sc1 lds
s_add_u32 m0, s53, 104448
s_add_u32 s51, s59, 30720
buffer_load_dwordx4 v12, s[32:35], s51 offen sc1 lds
s_add_u32 m0, s53, 106496
s_add_u32 s51, s59, 32768
buffer_load_dwordx4 v12, s[32:35], s51 offen sc1 lds
s_add_u32 m0, s53, 108544
s_add_u32 s51, s59, 34816
buffer_load_dwordx4 v12, s[32:35], s51 offen sc1 lds
s_add_u32 m0, s53, 110592
s_add_u32 s51, s59, 36864
buffer_load_dwordx4 v12, s[32:35], s51 offen sc1 lds
s_mul_i32 s53, s44, 6144
s_add_u32 s53, s53, s45
s_add_u32 m0, s53, 151552
s_add_u32 s51, s55, 63488
buffer_load_dwordx4 v12, s[32:35], s51 offen sc1 lds
s_add_u32 m0, s53, 153600
s_add_u32 s51, s55, 65536
buffer_load_dwordx4 v12, s[32:35], s51 offen sc1 lds
s_add_u32 m0, s53, 155648
s_add_u32 s51, s55, 67584
buffer_load_dwordx4 v12, s[32:35], s51 offen sc1 lds
s_waitcnt vmcnt(7)
s_barrier
s_mul_i32 s53, s44, 24576
s_add_u32 s53, s53, s45
s_add_u32 m0, s53, 0
s_add_u32 s51, s59, 38912
buffer_load_dwordx4 v12, s[32:35], s51 offen sc1 lds
s_add_u32 m0, s53, 2048
s_add_u32 s51, s59, 40960
buffer_load_dwordx4 v12, s[32:35], s51 offen sc1 lds
s_add_u32 m0, s53, 4096
s_add_u32 s51, s59, 43008
buffer_load_dwordx4 v12, s[32:35], s51 offen sc1 lds
s_add_u32 m0, s53, 6144
s_add_u32 s51, s59, 45056
buffer_load_dwordx4 v12, s[32:35], s51 offen sc1 lds
s_add_u32 m0, s53, 8192
s_add_u32 s51, s59, 47104
buffer_load_dwordx4 v12, s[32:35], s51 offen sc1 lds
s_add_u32 m0, s53, 10240
s_add_u32 s51, s59, 49152
buffer_load_dwordx4 v12, s[32:35], s51 offen sc1 lds
s_add_u32 m0, s53, 12288
s_add_u32 s51, s55, 51200
buffer_load_dwordx4 v12, s[32:35], s51 offen sc1 lds
s_add_u32 m0, s53, 14336
s_add_u32 s51, s55, 53248
buffer_load_dwordx4 v12, s[32:35], s51 offen sc1 lds
s_add_u32 m0, s53, 16384
s_add_u32 s51, s55, 55296
buffer_load_dwordx4 v12, s[32:35], s51 offen sc1 lds
s_add_u32 m0, s53, 18432
s_add_u32 s51, s55, 57344
buffer_load_dwordx4 v12, s[32:35], s51 offen sc1 lds
s_add_u32 m0, s53, 20480
s_add_u32 s51, s55, 59392
buffer_load_dwordx4 v12, s[32:35], s51 offen sc1 lds
s_add_u32 m0, s53, 22528
s_add_u32 s51, s55, 61440
buffer_load_dwordx4 v12, s[32:35], s51 offen sc1 lds
s_mul_i32 s53, s44, 2048
s_add_u32 s53, s53, s45
s_add_u32 m0, s53, 147456
s_add_u32 s51, s55, 69632
buffer_load_dwordx4 v12, s[32:35], s51 offen sc1 lds
v_mov_b32 v253, s75
s_branch L_P2_PRE
L_COMPUTE:
s_load_dwordx4 s[76:79], s[0:1], 64
s_setprio 3
v_and_b32 v1, 63, v0
s_and_b32 s20, s2, 3
s_lshl_b32 s20, s20, 2
s_bfe_u32 s46, s2, 0x20003
s_add_u32 s20, s20, s46
s_lshr_b32 s47, s2, 5
s_and_b32 s21, s2, 4
s_lshl_b32 s21, s21, 1
s_add_u32 s21, s21, s47
s_mov_b32 s39, 0x20000
s_mov_b32 s56, 0
s_cmp_eq_u32 s22, 3
s_cbranch_scc1 L_C_GW
s_cmp_eq_u32 s22, 2
s_cbranch_scc1 L_C_TOK
s_branch L_C_SETUP
L_C_GW:
v_lshlrev_b32 v140, 4, v1
v_mov_b64 v[144:145], 0
v_mov_b64 v[146:147], 0
ds_write_b128 v140, v[144:147] offset:30720
v_add_u32 v140, 49152, v140
ds_write_b128 v140, v[144:147] offset:30720
v_add_u32 v140, 49152, v140
ds_write_b128 v140, v[144:147] offset:30720
s_branch L_C_SETUP
L_C_TOK:
s_cmp_lg_u32 s2, 0
s_cbranch_scc1 L_C_CPF
s_memrealtime s[44:45]
v_mov_b32 v147, 0
s_waitcnt lgkmcnt(0)
s_add_u32 s32, s78, 0
s_addc_u32 s33, s79, 0
s_mov_b32 s34, 268435456
s_mov_b32 s35, 0x20000
s_mov_b32 s40, s76
s_mov_b32 s41, s77
s_mov_b32 s42, 256
s_mov_b32 s43, 0x20000
s_or_b32 s44, s44, 1
v_mov_b32 v146, s44
s_mov_b64 exec, 1
buffer_atomic_cmpswap v[146:147], v147, s[40:43], 0 offen sc1
s_mov_b64 exec, -1
L_C_CPF:
s_getpc_b64 s[70:71]
L_PC:
s_sub_u32 s70, s70, L_PC - L_SIDE_B
s_subb_u32 s71, s71, 0
L_C_SETUP:
s_setprio 0
v_lshrrev_b32 v140, 4, v1
v_and_b32 v141, 15, v1
v_lshrrev_b32 v142, 5, v1
v_lshlrev_b32 v142, 4, v142
v_and_b32 v143, 1, v140
v_lshl_add_u32 v142, v143, 2, v142
v_lshrrev_b32 v143, 2, v141
v_add_u32 v142, v142, v143
v_mul_u32_u24 v145, 480, v142
v_and_b32 v143, 3, v141
v_lshl_add_u32 v2, v143, 3, v145
v_mul_u32_u24 v144, 40, v143
v_add3_u32 v3, v145, v144, 32
v_lshrrev_b32 v144, 1, v141
v_xor_b32 v144, v144, v140
v_lshlrev_b32 v144, 4, v144
v_lshl_add_u32 v4, v141, 7, v144
v_xor_b32 v5, 64, v4
s_and_b32 s44, s20, 7
s_lshl_b32 s44, s44, 11
v_add_u32 v6, s44, v4
v_add_u32 v7, s44, v5
v_lshlrev_b32 v240, 4, v140
v_add_u32 v240, 147456, v240
s_mov_b32 s44, 4048155338
v_mov_b32 v146, s44
s_lshr_b32 s45, s21, 1
s_or_b32 s45, s45, s22
v_lshlrev_b32 v145, 2, v140
v_sub_u32 v145, v141, v145
v_subrev_u32 v150, 0, v145
v_subrev_u32 v151, 1, v145
v_subrev_u32 v152, 2, v145
v_subrev_u32 v153, 3, v145
v_cmp_gt_u32 vcc, 8, v150
v_cmp_gt_i32 s[72:73], -8, v150
v_mov_b32 v236, 0x3f803f80
v_cndmask_b32 v220, v146, 0, vcc
v_cndmask_b32 v224, v146, 0, s[72:73]
v_cmp_gt_u32 vcc, 8, v151
v_cmp_gt_i32 s[72:73], -8, v151
v_mov_b32 v237, 0x3f803f80
v_cndmask_b32 v221, v146, 0, vcc
v_cndmask_b32 v225, v146, 0, s[72:73]
v_cmp_gt_u32 vcc, 8, v152
v_cmp_gt_i32 s[72:73], -8, v152
v_mov_b32 v238, 0x3f803f80
v_cndmask_b32 v222, v146, 0, vcc
v_cndmask_b32 v226, v146, 0, s[72:73]
v_cmp_gt_u32 vcc, 8, v153
v_cmp_gt_i32 s[72:73], -8, v153
v_mov_b32 v239, 0x3f803f80
v_cndmask_b32 v223, v146, 0, vcc
v_cndmask_b32 v227, v146, 0, s[72:73]
s_cmp_eq_u32 s45, 0
s_cselect_b64 vcc, -1, 0
v_cndmask_b32 v228, v224, v146, vcc
v_cndmask_b32 v229, v225, v146, vcc
v_cndmask_b32 v230, v226, v146, vcc
v_cndmask_b32 v231, v227, v146, vcc
s_mov_b32 s44, 0xffff0000
v_ashrrev_i32 v154, 31, v150
v_ashrrev_i32 v155, 31, v151
v_bfi_b32 v232, s44, v155, v154
v_not_b32 v234, v232
v_ashrrev_i32 v154, 31, v152
v_ashrrev_i32 v155, 31, v153
v_bfi_b32 v233, s44, v155, v154
v_not_b32 v235, v233
s_mov_b64 s[48:49], 0xffff
s_mov_b32 s50, 0xffff0000
s_mov_b32 s51, 0
s_mov_b32 s52, 0
s_mov_b32 s53, 0xffff
s_mov_b32 s54, 0
s_mov_b32 s55, 0xffff0000
s_mov_b32 s63, 49152
s_mov_b32 s74, 128
s_mov_b32 s92, 1051011932
s_mov_b32 s93, 1051011932
s_lshl_b32 s94, s21, 3
s_lshl_b32 s95, s22, 1
s_add_u32 s94, s94, s95
s_mul_i32 s94, s94, 45056
s_mul_i32 s95, s20, 2816
s_add_u32 s94, s94, s95
s_add_u32 s95, s94, 45056
v_mov_b64 v[8:9], 0
v_mov_b64 v[10:11], 0
v_mov_b64 v[12:13], 0
v_mov_b64 v[14:15], 0
v_mov_b64 v[16:17], 0
v_mov_b64 v[18:19], 0
v_mov_b64 v[20:21], 0
v_mov_b64 v[22:23], 0
v_mov_b64 v[24:25], 0
v_mov_b64 v[26:27], 0
v_mov_b64 v[28:29], 0
v_mov_b64 v[30:31], 0
v_mov_b64 v[32:33], 0
v_mov_b64 v[34:35], 0
v_mov_b64 v[36:37], 0
v_mov_b64 v[38:39], 0
v_mov_b64 v[40:41], 0
v_mov_b64 v[42:43], 0
v_mov_b64 v[44:45], 0
v_mov_b64 v[46:47], 0
v_mov_b64 v[48:49], 0
v_mov_b64 v[50:51], 0
v_mov_b64 v[52:53], 0
v_mov_b64 v[54:55], 0
v_mov_b64 v[56:57], 0
v_mov_b64 v[58:59], 0
v_mov_b64 v[60:61], 0
v_mov_b64 v[62:63], 0
v_mov_b64 v[64:65], 0
v_mov_b64 v[66:67], 0
v_mov_b64 v[68:69], 0
v_mov_b64 v[70:71], 0
v_mov_b64 v[72:73], 0
v_mov_b64 v[74:75], 0
v_mov_b64 v[76:77], 0
v_mov_b64 v[78:79], 0
v_mov_b64 v[80:81], 0
v_mov_b64 v[82:83], 0
v_mov_b64 v[84:85], 0
v_mov_b64 v[86:87], 0
v_mov_b64 v[88:89], 0
v_mov_b64 v[90:91], 0
v_mov_b64 v[92:93], 0
v_mov_b64 v[94:95], 0
v_mov_b64 v[96:97], 0
v_mov_b64 v[98:99], 0
v_mov_b64 v[100:101], 0
v_mov_b64 v[102:103], 0
v_mov_b64 v[104:105], 0
v_mov_b64 v[106:107], 0
v_mov_b64 v[108:109], 0
v_mov_b64 v[110:111], 0
v_mov_b64 v[112:113], 0
v_mov_b64 v[114:115], 0
v_mov_b64 v[116:117], 0
v_mov_b64 v[118:119], 0
v_mov_b64 v[120:121], 0
v_mov_b64 v[122:123], 0
v_mov_b64 v[124:125], 0
v_mov_b64 v[126:127], 0
v_mov_b64 v[128:129], 0
v_mov_b64 v[130:131], 0
v_mov_b64 v[132:133], 0
v_mov_b64 v[134:135], 0
v_mov_b64 v[136:137], 0
v_mov_b64 v[138:139], 0
s_waitcnt vmcnt(0) lgkmcnt(0)
s_add_u32 s32, s78, 0
s_addc_u32 s33, s79, 0
s_mov_b32 s34, 268435456
s_mov_b32 s35, 0x20000
s_mov_b32 s40, s76
s_mov_b32 s41, s77
s_mov_b32 s42, 256
s_mov_b32 s43, 0x20000
s_setprio 0
L_C_GO:
s_mov_b32 s44, 0
s_mov_b32 s45, 0
s_cmp_eq_u32 s22, 1
s_cbranch_scc1 L_W1
s_cmp_eq_u32 s22, 2
s_cbranch_scc1 L_W2
s_cmp_eq_u32 s22, 3
s_cbranch_scc1 L_W3
s_barrier
ds_read_b128 v[180:183], v4 offset:32768
ds_read_b128 v[184:187], v4 offset:34816
ds_read_b64_tr_b16 v[140:141], v2 offset:0
ds_read_b64_tr_b16 v[142:143], v2 offset:3840
ds_read_b128 v[188:191], v4 offset:30720
ds_read_b64_tr_b16 v[144:145], v2 offset:40
ds_read_b64_tr_b16 v[146:147], v2 offset:3880
ds_read_b64_tr_b16 v[148:149], v2 offset:80
ds_read_b64_tr_b16 v[150:151], v2 offset:3920
ds_read_b64_tr_b16 v[152:153], v2 offset:120
ds_read_b64_tr_b16 v[154:155], v2 offset:3960
ds_read_b64_tr_b16 v[156:157], v3 offset:0
ds_read_b64_tr_b16 v[158:159], v3 offset:3840
s_branch L_LB0
.p2align 6
L_LA0:
s_barrier
v_mfma_f32_16x16x32_bf16 v[88:91], v[192:195], v[160:163], v[88:91]
ds_read_b128 v[180:183], v4 offset:32768
ds_read_b128 v[184:187], v4 offset:34816
v_mfma_f32_16x16x32_bf16 v[108:111], v[196:199], v[160:163], v[108:111]
ds_read_b64_tr_b16 v[140:141], v2 offset:0
v_mfma_f32_16x16x32_bf16 v[136:139], v[200:203], v[160:163], v[136:139]
ds_read_b64_tr_b16 v[142:143], v2 offset:3840
v_mfma_f32_16x16x32_bf16 v[92:95], v[192:195], v[164:167], v[92:95]
ds_read_b128 v[188:191], v4 offset:30720
ds_read_b64_tr_b16 v[144:145], v2 offset:40
v_mfma_f32_16x16x32_bf16 v[112:115], v[196:199], v[164:167], v[112:115]
ds_read_b64_tr_b16 v[146:147], v2 offset:3880
v_mfma_f32_16x16x32_bf16 v[96:99], v[192:195], v[168:171], v[96:99]
ds_read_b64_tr_b16 v[148:149], v2 offset:80
v_mfma_f32_16x16x32_bf16 v[116:119], v[196:199], v[168:171], v[116:119]
ds_read_b64_tr_b16 v[150:151], v2 offset:3920
v_mfma_f32_16x16x32_bf16 v[100:103], v[192:195], v[172:175], v[100:103]
ds_read_b64_tr_b16 v[152:153], v2 offset:120
v_mfma_f32_16x16x32_bf16 v[120:123], v[196:199], v[172:175], v[120:123]
ds_read_b64_tr_b16 v[154:155], v2 offset:3960
v_mfma_f32_16x16x32_bf16 v[104:107], v[192:195], v[176:179], v[104:107]
ds_read_b64_tr_b16 v[156:157], v3 offset:0
v_mfma_f32_16x16x32_bf16 v[124:127], v[196:199], v[176:179], v[124:127]
ds_read_b64_tr_b16 v[158:159], v3 offset:3840
L_LB0:
s_waitcnt lgkmcnt(8)
v_mfma_f32_16x16x32_bf16 v[8:11], v[140:143], v[180:183], v[8:11]
ds_read_b64_tr_b16 v[160:161], v2 offset:160
v_mfma_f32_16x16x32_bf16 v[28:31], v[140:143], v[184:187], v[28:31]
ds_read_b64_tr_b16 v[162:163], v2 offset:4000
s_waitcnt lgkmcnt(8)
v_mfma_f32_16x16x32_bf16 v[12:15], v[144:147], v[180:183], v[12:15]
ds_read_b64_tr_b16 v[164:165], v2 offset:200
v_mfma_f32_16x16x32_bf16 v[32:35], v[144:147], v[184:187], v[32:35]
ds_read_b64_tr_b16 v[166:167], v2 offset:4040
s_waitcnt lgkmcnt(8)
v_mfma_f32_16x16x32_bf16 v[16:19], v[148:151], v[180:183], v[16:19]
ds_read_b64_tr_b16 v[168:169], v2 offset:240
ds_read_b64_tr_b16 v[170:171], v2 offset:4080
v_mfma_f32_16x16x32_bf16 v[36:39], v[148:151], v[184:187], v[36:39]
ds_read_b128 v[192:195], v5 offset:32768
s_waitcnt lgkmcnt(9)
v_mfma_f32_16x16x32_bf16 v[20:23], v[152:155], v[180:183], v[20:23]
ds_read_b64_tr_b16 v[172:173], v2 offset:280
ds_read_b64_tr_b16 v[174:175], v2 offset:4120
v_mfma_f32_16x16x32_bf16 v[40:43], v[152:155], v[184:187], v[40:43]
ds_read_b128 v[196:199], v5 offset:34816
s_waitcnt lgkmcnt(10)
v_mfma_f32_16x16x32_bf16 v[24:27], v[156:159], v[180:183], v[24:27]
ds_read_b64_tr_b16 v[176:177], v3 offset:160
ds_read_b64_tr_b16 v[178:179], v3 offset:4000
v_mfma_f32_16x16x32_bf16 v[44:47], v[156:159], v[184:187], v[44:47]
ds_read_b128 v[200:203], v5 offset:30720
s_waitcnt lgkmcnt(11)
v_mfma_f32_16x16x32_bf16 v[48:51], v[160:163], v[180:183], v[48:51]
ds_read_b64_tr_b16 v[140:141], v2 offset:320
v_mfma_f32_16x16x32_bf16 v[68:71], v[160:163], v[184:187], v[68:71]
ds_read_b64_tr_b16 v[142:143], v2 offset:4160
v_mfma_f32_16x16x32_bf16 v[128:131], v[160:163], v[188:191], v[128:131]
s_waitcnt lgkmcnt(11)
v_mfma_f32_16x16x32_bf16 v[52:55], v[164:167], v[180:183], v[52:55]
ds_read_b64_tr_b16 v[144:145], v2 offset:360
v_mfma_f32_16x16x32_bf16 v[72:75], v[164:167], v[184:187], v[72:75]
ds_read_b64_tr_b16 v[146:147], v2 offset:4200
s_waitcnt lgkmcnt(11)
v_mfma_f32_16x16x32_bf16 v[56:59], v[168:171], v[180:183], v[56:59]
ds_read_b64_tr_b16 v[148:149], v2 offset:400
v_mfma_f32_16x16x32_bf16 v[76:79], v[168:171], v[184:187], v[76:79]
ds_read_b64_tr_b16 v[150:151], v2 offset:4240
v_mfma_f32_16x16x32_bf16 v[132:135], v[168:171], v[188:191], v[132:135]
s_waitcnt lgkmcnt(10)
v_mfma_f32_16x16x32_bf16 v[60:63], v[172:175], v[180:183], v[60:63]
ds_read_b64_tr_b16 v[152:153], v2 offset:440
v_mfma_f32_16x16x32_bf16 v[80:83], v[172:175], v[184:187], v[80:83]
ds_read_b64_tr_b16 v[154:155], v2 offset:4280
s_waitcnt lgkmcnt(9)
v_mfma_f32_16x16x32_bf16 v[64:67], v[176:179], v[180:183], v[64:67]
ds_read_b64_tr_b16 v[156:157], v3 offset:320
ds_read_b64_tr_b16 v[158:159], v3 offset:4160
v_mfma_f32_16x16x32_bf16 v[84:87], v[176:179], v[184:187], v[84:87]
ds_read_b64_tr_b16 v[160:161], v2 offset:15360
ds_read_b64_tr_b16 v[162:163], v2 offset:19200
s_waitcnt lgkmcnt(10)
v_mfma_f32_16x16x32_bf16 v[88:91], v[180:183], v[140:143], v[88:91]
ds_read_b64_tr_b16 v[164:165], v2 offset:15400
s_add_u32 s45, s45, 1
v_mfma_f32_16x16x32_bf16 v[108:111], v[184:187], v[140:143], v[108:111]
ds_read_b64_tr_b16 v[166:167], v2 offset:19240
v_mfma_f32_16x16x32_bf16 v[136:139], v[188:191], v[140:143], v[136:139]
s_waitcnt lgkmcnt(10)
v_mfma_f32_16x16x32_bf16 v[92:95], v[180:183], v[144:147], v[92:95]
ds_read_b64_tr_b16 v[168:169], v2 offset:15440
s_cmp_eq_u32 s45, 3
v_mfma_f32_16x16x32_bf16 v[112:115], v[184:187], v[144:147], v[112:115]
ds_read_b64_tr_b16 v[170:171], v2 offset:19280
s_waitcnt lgkmcnt(10)
v_mfma_f32_16x16x32_bf16 v[96:99], v[180:183], v[148:151], v[96:99]
ds_read_b64_tr_b16 v[172:173], v2 offset:15480
s_cselect_b32 s46, 4294868992, s63
v_mfma_f32_16x16x32_bf16 v[116:119], v[184:187], v[148:151], v[116:119]
ds_read_b64_tr_b16 v[174:175], v2 offset:19320
s_waitcnt lgkmcnt(10)
v_mfma_f32_16x16x32_bf16 v[100:103], v[180:183], v[152:155], v[100:103]
ds_read_b64_tr_b16 v[176:177], v3 offset:15360
s_cselect_b32 s45, 0, s45
v_mfma_f32_16x16x32_bf16 v[120:123], v[184:187], v[152:155], v[120:123]
ds_read_b64_tr_b16 v[178:179], v3 offset:19200
s_waitcnt lgkmcnt(10)
v_mfma_f32_16x16x32_bf16 v[104:107], v[180:183], v[156:159], v[104:107]
ds_read_b64_tr_b16 v[140:141], v2 offset:15520
v_mfma_f32_16x16x32_bf16 v[124:127], v[184:187], v[156:159], v[124:127]
ds_read_b64_tr_b16 v[142:143], v2 offset:19360
s_waitcnt lgkmcnt(10)
v_mfma_f32_16x16x32_bf16 v[8:11], v[160:163], v[192:195], v[8:11]
ds_read_b64_tr_b16 v[144:145], v2 offset:15560
ds_read_b64_tr_b16 v[146:147], v2 offset:19400
v_mfma_f32_16x16x32_bf16 v[28:31], v[160:163], v[196:199], v[28:31]
ds_read_b64_tr_b16 v[148:149], v2 offset:15600
ds_read_b64_tr_b16 v[150:151], v2 offset:19440
s_waitcnt lgkmcnt(12)
v_mfma_f32_16x16x32_bf16 v[12:15], v[164:167], v[192:195], v[12:15]
ds_read_b64_tr_b16 v[152:153], v2 offset:15640
v_mfma_f32_16x16x32_bf16 v[32:35], v[164:167], v[196:199], v[32:35]
ds_read_b64_tr_b16 v[154:155], v2 offset:19480
s_waitcnt lgkmcnt(12)
v_mfma_f32_16x16x32_bf16 v[16:19], v[168:171], v[192:195], v[16:19]
ds_read_b64_tr_b16 v[156:157], v3 offset:15520
v_mfma_f32_16x16x32_bf16 v[36:39], v[168:171], v[196:199], v[36:39]
ds_read_b64_tr_b16 v[158:159], v3 offset:19360
s_waitcnt lgkmcnt(12)
v_mfma_f32_16x16x32_bf16 v[20:23], v[172:175], v[192:195], v[20:23]
ds_read_b64_tr_b16 v[160:161], v2 offset:15680
v_mfma_f32_16x16x32_bf16 v[40:43], v[172:175], v[196:199], v[40:43]
ds_read_b64_tr_b16 v[162:163], v2 offset:19520
s_waitcnt lgkmcnt(12)
v_mfma_f32_16x16x32_bf16 v[24:27], v[176:179], v[192:195], v[24:27]
ds_read_b64_tr_b16 v[164:165], v2 offset:15720
v_mfma_f32_16x16x32_bf16 v[44:47], v[176:179], v[196:199], v[44:47]
ds_read_b64_tr_b16 v[166:167], v2 offset:19560
s_waitcnt lgkmcnt(12)
v_mfma_f32_16x16x32_bf16 v[48:51], v[140:143], v[192:195], v[48:51]
ds_read_b64_tr_b16 v[168:169], v2 offset:15760
v_add_u32 v4, s46, v4
v_mfma_f32_16x16x32_bf16 v[68:71], v[140:143], v[196:199], v[68:71]
ds_read_b64_tr_b16 v[170:171], v2 offset:19600
v_mfma_f32_16x16x32_bf16 v[128:131], v[140:143], v[200:203], v[128:131]
s_waitcnt lgkmcnt(12)
v_mfma_f32_16x16x32_bf16 v[52:55], v[144:147], v[192:195], v[52:55]
ds_read_b64_tr_b16 v[172:173], v2 offset:15800
v_mfma_f32_16x16x32_bf16 v[72:75], v[144:147], v[196:199], v[72:75]
ds_read_b64_tr_b16 v[174:175], v2 offset:19640
s_waitcnt lgkmcnt(12)
v_mfma_f32_16x16x32_bf16 v[56:59], v[148:151], v[192:195], v[56:59]
ds_read_b64_tr_b16 v[176:177], v3 offset:15680
v_mfma_f32_16x16x32_bf16 v[76:79], v[148:151], v[196:199], v[76:79]
ds_read_b64_tr_b16 v[178:179], v3 offset:19520
v_mfma_f32_16x16x32_bf16 v[132:135], v[148:151], v[200:203], v[132:135]
s_waitcnt lgkmcnt(12)
v_mfma_f32_16x16x32_bf16 v[60:63], v[152:155], v[192:195], v[60:63]
v_add_u32 v5, s46, v5
v_add_u32 v2, s46, v2
v_mfma_f32_16x16x32_bf16 v[80:83], v[152:155], v[196:199], v[80:83]
v_add_u32 v3, s46, v3
s_waitcnt lgkmcnt(10)
v_mfma_f32_16x16x32_bf16 v[64:67], v[156:159], v[192:195], v[64:67]
s_add_u32 s44, s44, 1
s_cmp_eq_u32 s44, 10
v_mfma_f32_16x16x32_bf16 v[84:87], v[156:159], v[196:199], v[84:87]
s_waitcnt lgkmcnt(0)
s_cbranch_scc0 L_LA0
L_T0:
v_mov_b32 v253, 148992
s_waitcnt lgkmcnt(0)
ds_read_b32 v253, v253
v_mfma_f32_16x16x32_bf16 v[88:91], v[192:195], v[160:163], v[88:91]
v_lshlrev_b32 v2, 3, v1
v_add_u32 v5, 126976, v2
v_mfma_f32_16x16x32_bf16 v[108:111], v[196:199], v[160:163], v[108:111]
v_add_u32 v3, 126976, v2
v_add_u32 v4, 132096, v2
v_mfma_f32_16x16x32_bf16 v[136:139], v[200:203], v[160:163], v[136:139]
v_cvt_pk_bf16_f32 v140, v68, v69
v_cvt_pk_bf16_f32 v141, v70, v71
v_mfma_f32_16x16x32_bf16 v[92:95], v[192:195], v[164:167], v[92:95]
ds_write_b64 v4, v[140:141] offset:0
v_cvt_pk_bf16_f32 v144, v72, v73
v_mfma_f32_16x16x32_bf16 v[112:115], v[196:199], v[164:167], v[112:115]
v_cvt_pk_bf16_f32 v145, v74, v75
ds_write_b64 v4, v[144:145] offset:512
v_mfma_f32_16x16x32_bf16 v[96:99], v[192:195], v[168:171], v[96:99]
v_cvt_pk_bf16_f32 v148, v76, v77
v_cvt_pk_bf16_f32 v149, v78, v79
v_mfma_f32_16x16x32_bf16 v[116:119], v[196:199], v[168:171], v[116:119]
ds_write_b64 v4, v[148:149] offset:1024
v_cvt_pk_bf16_f32 v152, v80, v81
v_mfma_f32_16x16x32_bf16 v[100:103], v[192:195], v[172:175], v[100:103]
v_cvt_pk_bf16_f32 v153, v82, v83
ds_write_b64 v4, v[152:153] offset:1536
v_mfma_f32_16x16x32_bf16 v[120:123], v[196:199], v[172:175], v[120:123]
v_cvt_pk_bf16_f32 v142, v84, v85
v_cvt_pk_bf16_f32 v143, v86, v87
v_mfma_f32_16x16x32_bf16 v[104:107], v[192:195], v[176:179], v[104:107]
ds_write_b64 v4, v[142:143] offset:2048
v_cvt_pk_bf16_f32 v146, v84, v85
v_mfma_f32_16x16x32_bf16 v[124:127], v[196:199], v[176:179], v[124:127]
v_cvt_pk_bf16_f32 v147, v86, v87
v_cvt_pk_bf16_f32 v150, v84, v85
v_cvt_pk_bf16_f32 v151, v86, v87
v_cvt_pk_bf16_f32 v154, v84, v85
v_cvt_pk_bf16_f32 v155, v86, v87
v_cvt_pk_bf16_f32 v242, v128, v129
v_cvt_pk_bf16_f32 v243, v130, v131
ds_write_b64 v5, v[242:243] offset:0
s_setprio 2
v_cvt_pk_bf16_f32 v250, v44, v45
v_cvt_pk_bf16_f32 v244, v132, v133
v_cvt_pk_bf16_f32 v245, v134, v135
ds_write_b64 v5, v[244:245] offset:1024
v_cvt_pk_bf16_f32 v251, v46, v47
v_cvt_pk_bf16_f32 v68, v28, v29
v_cvt_pk_bf16_f32 v246, v136, v137
v_cvt_pk_bf16_f32 v247, v138, v139
ds_write_b64 v5, v[246:247] offset:2560
v_cvt_pk_bf16_f32 v69, v30, v31
v_cvt_pk_bf16_f32 v72, v32, v33
v_cvt_pk_bf16_f32 v176, v108, v109
v_cvt_pk_bf16_f32 v177, v110, v111
ds_write_b64 v4, v[176:177] offset:2560
v_cvt_pk_bf16_f32 v73, v34, v35
v_cvt_pk_bf16_f32 v76, v36, v37
v_cvt_pk_bf16_f32 v182, v112, v113
v_cvt_pk_bf16_f32 v183, v114, v115
ds_write_b64 v4, v[182:183] offset:3072
v_cvt_pk_bf16_f32 v77, v38, v39
v_cvt_pk_bf16_f32 v80, v40, v41
v_cvt_pk_bf16_f32 v188, v116, v117
v_cvt_pk_bf16_f32 v189, v118, v119
ds_write_b64 v4, v[188:189] offset:3584
v_cvt_pk_bf16_f32 v81, v42, v43
v_cndmask_b32 v70, 0, v250, s[48:49]
v_cvt_pk_bf16_f32 v194, v120, v121
v_cvt_pk_bf16_f32 v195, v122, v123
ds_write_b64 v4, v[194:195] offset:4096
v_cndmask_b32 v71, 0, v251, s[48:49]
v_cndmask_b32 v74, 0, v250, s[50:51]
v_cvt_pk_bf16_f32 v200, v124, v125
v_cvt_pk_bf16_f32 v201, v126, v127
ds_write_b64 v4, v[200:201] offset:4608
v_cndmask_b32 v75, 0, v251, s[50:51]
v_cndmask_b32 v78, 0, v250, s[52:53]
v_cndmask_b32 v79, 0, v251, s[52:53]
v_cndmask_b32 v82, 0, v250, s[54:55]
v_cndmask_b32 v83, 0, v251, s[54:55]
s_branch L_ATT
L_W1:
s_barrier
ds_read_b128 v[180:183], v4 offset:36864
ds_read_b128 v[184:187], v4 offset:38912
ds_read_b64_tr_b16 v[140:141], v2 offset:0
ds_read_b64_tr_b16 v[142:143], v2 offset:3840
ds_read_b128 v[188:191], v4 offset:30720
ds_read_b64_tr_b16 v[144:145], v2 offset:40
ds_read_b64_tr_b16 v[146:147], v2 offset:3880
ds_read_b64_tr_b16 v[148:149], v2 offset:80
ds_read_b64_tr_b16 v[150:151], v2 offset:3920
ds_read_b64_tr_b16 v[152:153], v2 offset:120
ds_read_b64_tr_b16 v[154:155], v2 offset:3960
ds_read_b64_tr_b16 v[156:157], v3 offset:0
ds_read_b64_tr_b16 v[158:159], v3 offset:3840
s_branch L_LB1
.p2align 6
L_LA1:
s_barrier
v_mfma_f32_16x16x32_bf16 v[88:91], v[192:195], v[160:163], v[88:91]
ds_read_b128 v[180:183], v4 offset:36864
ds_read_b128 v[184:187], v4 offset:38912
v_mfma_f32_16x16x32_bf16 v[108:111], v[196:199], v[160:163], v[108:111]
ds_read_b64_tr_b16 v[140:141], v2 offset:0
ds_read_b64_tr_b16 v[142:143], v2 offset:3840
v_mfma_f32_16x16x32_bf16 v[92:95], v[192:195], v[164:167], v[92:95]
ds_read_b128 v[188:191], v4 offset:30720
v_mfma_f32_16x16x32_bf16 v[112:115], v[196:199], v[164:167], v[112:115]
ds_read_b64_tr_b16 v[144:145], v2 offset:40
v_mfma_f32_16x16x32_bf16 v[136:139], v[200:203], v[164:167], v[136:139]
ds_read_b64_tr_b16 v[146:147], v2 offset:3880
v_mfma_f32_16x16x32_bf16 v[96:99], v[192:195], v[168:171], v[96:99]
ds_read_b64_tr_b16 v[148:149], v2 offset:80
v_mfma_f32_16x16x32_bf16 v[116:119], v[196:199], v[168:171], v[116:119]
ds_read_b64_tr_b16 v[150:151], v2 offset:3920
v_mfma_f32_16x16x32_bf16 v[100:103], v[192:195], v[172:175], v[100:103]
ds_read_b64_tr_b16 v[152:153], v2 offset:120
v_mfma_f32_16x16x32_bf16 v[120:123], v[196:199], v[172:175], v[120:123]
ds_read_b64_tr_b16 v[154:155], v2 offset:3960
v_mfma_f32_16x16x32_bf16 v[104:107], v[192:195], v[176:179], v[104:107]
ds_read_b64_tr_b16 v[156:157], v3 offset:0
v_mfma_f32_16x16x32_bf16 v[124:127], v[196:199], v[176:179], v[124:127]
ds_read_b64_tr_b16 v[158:159], v3 offset:3840
L_LB1:
s_waitcnt lgkmcnt(8)
v_mfma_f32_16x16x32_bf16 v[8:11], v[140:143], v[180:183], v[8:11]
ds_read_b64_tr_b16 v[160:161], v2 offset:160
v_mfma_f32_16x16x32_bf16 v[28:31], v[140:143], v[184:187], v[28:31]
ds_read_b64_tr_b16 v[162:163], v2 offset:4000
s_waitcnt lgkmcnt(8)
v_mfma_f32_16x16x32_bf16 v[12:15], v[144:147], v[180:183], v[12:15]
ds_read_b64_tr_b16 v[164:165], v2 offset:200
v_mfma_f32_16x16x32_bf16 v[32:35], v[144:147], v[184:187], v[32:35]
ds_read_b64_tr_b16 v[166:167], v2 offset:4040
s_waitcnt lgkmcnt(8)
v_mfma_f32_16x16x32_bf16 v[16:19], v[148:151], v[180:183], v[16:19]
ds_read_b64_tr_b16 v[168:169], v2 offset:240
ds_read_b64_tr_b16 v[170:171], v2 offset:4080
v_mfma_f32_16x16x32_bf16 v[36:39], v[148:151], v[184:187], v[36:39]
ds_read_b128 v[192:195], v5 offset:36864
s_waitcnt lgkmcnt(9)
v_mfma_f32_16x16x32_bf16 v[20:23], v[152:155], v[180:183], v[20:23]
ds_read_b64_tr_b16 v[172:173], v2 offset:280
ds_read_b64_tr_b16 v[174:175], v2 offset:4120
v_mfma_f32_16x16x32_bf16 v[40:43], v[152:155], v[184:187], v[40:43]
ds_read_b128 v[196:199], v5 offset:38912
s_waitcnt lgkmcnt(10)
v_mfma_f32_16x16x32_bf16 v[24:27], v[156:159], v[180:183], v[24:27]
ds_read_b64_tr_b16 v[176:177], v3 offset:160
ds_read_b64_tr_b16 v[178:179], v3 offset:4000
v_mfma_f32_16x16x32_bf16 v[44:47], v[156:159], v[184:187], v[44:47]
ds_read_b128 v[200:203], v5 offset:30720
s_waitcnt lgkmcnt(11)
v_mfma_f32_16x16x32_bf16 v[48:51], v[160:163], v[180:183], v[48:51]
ds_read_b64_tr_b16 v[140:141], v2 offset:320
v_mfma_f32_16x16x32_bf16 v[68:71], v[160:163], v[184:187], v[68:71]
ds_read_b64_tr_b16 v[142:143], v2 offset:4160
s_waitcnt lgkmcnt(11)
v_mfma_f32_16x16x32_bf16 v[52:55], v[164:167], v[180:183], v[52:55]
ds_read_b64_tr_b16 v[144:145], v2 offset:360
v_mfma_f32_16x16x32_bf16 v[72:75], v[164:167], v[184:187], v[72:75]
ds_read_b64_tr_b16 v[146:147], v2 offset:4200
v_mfma_f32_16x16x32_bf16 v[128:131], v[164:167], v[188:191], v[128:131]
s_waitcnt lgkmcnt(11)
v_mfma_f32_16x16x32_bf16 v[56:59], v[168:171], v[180:183], v[56:59]
ds_read_b64_tr_b16 v[148:149], v2 offset:400
v_mfma_f32_16x16x32_bf16 v[76:79], v[168:171], v[184:187], v[76:79]
ds_read_b64_tr_b16 v[150:151], v2 offset:4240
s_waitcnt lgkmcnt(10)
v_mfma_f32_16x16x32_bf16 v[60:63], v[172:175], v[180:183], v[60:63]
ds_read_b64_tr_b16 v[152:153], v2 offset:440
v_mfma_f32_16x16x32_bf16 v[80:83], v[172:175], v[184:187], v[80:83]
ds_read_b64_tr_b16 v[154:155], v2 offset:4280
v_mfma_f32_16x16x32_bf16 v[132:135], v[172:175], v[188:191], v[132:135]
s_waitcnt lgkmcnt(9)
v_mfma_f32_16x16x32_bf16 v[64:67], v[176:179], v[180:183], v[64:67]
ds_read_b64_tr_b16 v[156:157], v3 offset:320
ds_read_b64_tr_b16 v[158:159], v3 offset:4160
v_mfma_f32_16x16x32_bf16 v[84:87], v[176:179], v[184:187], v[84:87]
ds_read_b64_tr_b16 v[160:161], v2 offset:15360
ds_read_b64_tr_b16 v[162:163], v2 offset:19200
s_waitcnt lgkmcnt(10)
v_mfma_f32_16x16x32_bf16 v[88:91], v[180:183], v[140:143], v[88:91]
ds_read_b64_tr_b16 v[164:165], v2 offset:15400
s_add_u32 s45, s45, 1
v_mfma_f32_16x16x32_bf16 v[108:111], v[184:187], v[140:143], v[108:111]
ds_read_b64_tr_b16 v[166:167], v2 offset:19240
s_waitcnt lgkmcnt(10)
v_mfma_f32_16x16x32_bf16 v[92:95], v[180:183], v[144:147], v[92:95]
ds_read_b64_tr_b16 v[168:169], v2 offset:15440
s_cmp_eq_u32 s45, 3
v_mfma_f32_16x16x32_bf16 v[112:115], v[184:187], v[144:147], v[112:115]
ds_read_b64_tr_b16 v[170:171], v2 offset:19280
v_mfma_f32_16x16x32_bf16 v[136:139], v[188:191], v[144:147], v[136:139]
s_waitcnt lgkmcnt(10)
v_mfma_f32_16x16x32_bf16 v[96:99], v[180:183], v[148:151], v[96:99]
ds_read_b64_tr_b16 v[172:173], v2 offset:15480
s_cselect_b32 s46, 4294868992, s63
v_mfma_f32_16x16x32_bf16 v[116:119], v[184:187], v[148:151], v[116:119]
ds_read_b64_tr_b16 v[174:175], v2 offset:19320
s_waitcnt lgkmcnt(10)
v_mfma_f32_16x16x32_bf16 v[100:103], v[180:183], v[152:155], v[100:103]
ds_read_b64_tr_b16 v[176:177], v3 offset:15360
s_cselect_b32 s45, 0, s45
v_mfma_f32_16x16x32_bf16 v[120:123], v[184:187], v[152:155], v[120:123]
ds_read_b64_tr_b16 v[178:179], v3 offset:19200
s_waitcnt lgkmcnt(10)
v_mfma_f32_16x16x32_bf16 v[104:107], v[180:183], v[156:159], v[104:107]
ds_read_b64_tr_b16 v[140:141], v2 offset:15520
v_mfma_f32_16x16x32_bf16 v[124:127], v[184:187], v[156:159], v[124:127]
ds_read_b64_tr_b16 v[142:143], v2 offset:19360
s_waitcnt lgkmcnt(10)
v_mfma_f32_16x16x32_bf16 v[8:11], v[160:163], v[192:195], v[8:11]
ds_read_b64_tr_b16 v[144:145], v2 offset:15560
ds_read_b64_tr_b16 v[146:147], v2 offset:19400
v_mfma_f32_16x16x32_bf16 v[28:31], v[160:163], v[196:199], v[28:31]
ds_read_b64_tr_b16 v[148:149], v2 offset:15600
ds_read_b64_tr_b16 v[150:151], v2 offset:19440
s_waitcnt lgkmcnt(12)
v_mfma_f32_16x16x32_bf16 v[12:15], v[164:167], v[192:195], v[12:15]
ds_read_b64_tr_b16 v[152:153], v2 offset:15640
v_mfma_f32_16x16x32_bf16 v[32:35], v[164:167], v[196:199], v[32:35]
ds_read_b64_tr_b16 v[154:155], v2 offset:19480
s_waitcnt lgkmcnt(12)
v_mfma_f32_16x16x32_bf16 v[16:19], v[168:171], v[192:195], v[16:19]
ds_read_b64_tr_b16 v[156:157], v3 offset:15520
v_mfma_f32_16x16x32_bf16 v[36:39], v[168:171], v[196:199], v[36:39]
ds_read_b64_tr_b16 v[158:159], v3 offset:19360
s_waitcnt lgkmcnt(12)
v_mfma_f32_16x16x32_bf16 v[20:23], v[172:175], v[192:195], v[20:23]
ds_read_b64_tr_b16 v[160:161], v2 offset:15680
v_mfma_f32_16x16x32_bf16 v[40:43], v[172:175], v[196:199], v[40:43]
ds_read_b64_tr_b16 v[162:163], v2 offset:19520
s_waitcnt lgkmcnt(12)
v_mfma_f32_16x16x32_bf16 v[24:27], v[176:179], v[192:195], v[24:27]
ds_read_b64_tr_b16 v[164:165], v2 offset:15720
v_mfma_f32_16x16x32_bf16 v[44:47], v[176:179], v[196:199], v[44:47]
ds_read_b64_tr_b16 v[166:167], v2 offset:19560
s_waitcnt lgkmcnt(12)
v_mfma_f32_16x16x32_bf16 v[48:51], v[140:143], v[192:195], v[48:51]
ds_read_b64_tr_b16 v[168:169], v2 offset:15760
v_add_u32 v4, s46, v4
v_mfma_f32_16x16x32_bf16 v[68:71], v[140:143], v[196:199], v[68:71]
ds_read_b64_tr_b16 v[170:171], v2 offset:19600
s_waitcnt lgkmcnt(12)
v_mfma_f32_16x16x32_bf16 v[52:55], v[144:147], v[192:195], v[52:55]
ds_read_b64_tr_b16 v[172:173], v2 offset:15800
v_mfma_f32_16x16x32_bf16 v[72:75], v[144:147], v[196:199], v[72:75]
ds_read_b64_tr_b16 v[174:175], v2 offset:19640
v_mfma_f32_16x16x32_bf16 v[128:131], v[144:147], v[200:203], v[128:131]
s_waitcnt lgkmcnt(12)
v_mfma_f32_16x16x32_bf16 v[56:59], v[148:151], v[192:195], v[56:59]
ds_read_b64_tr_b16 v[176:177], v3 offset:15680
v_mfma_f32_16x16x32_bf16 v[76:79], v[148:151], v[196:199], v[76:79]
ds_read_b64_tr_b16 v[178:179], v3 offset:19520
s_waitcnt lgkmcnt(12)
v_mfma_f32_16x16x32_bf16 v[60:63], v[152:155], v[192:195], v[60:63]
v_add_u32 v5, s46, v5
v_mfma_f32_16x16x32_bf16 v[80:83], v[152:155], v[196:199], v[80:83]
v_add_u32 v2, s46, v2
v_add_u32 v3, s46, v3
v_mfma_f32_16x16x32_bf16 v[132:135], v[152:155], v[200:203], v[132:135]
s_waitcnt lgkmcnt(10)
v_mfma_f32_16x16x32_bf16 v[64:67], v[156:159], v[192:195], v[64:67]
s_add_u32 s44, s44, 1
s_cmp_eq_u32 s44, 10
v_mfma_f32_16x16x32_bf16 v[84:87], v[156:159], v[196:199], v[84:87]
s_waitcnt lgkmcnt(0)
s_cbranch_scc0 L_LA1
L_T1:
v_mov_b32 v253, 148992
s_waitcnt lgkmcnt(0)
ds_read_b32 v253, v253
v_mfma_f32_16x16x32_bf16 v[88:91], v[192:195], v[160:163], v[88:91]
v_lshlrev_b32 v2, 3, v1
v_add_u32 v5, 126976, v2
v_mfma_f32_16x16x32_bf16 v[108:111], v[196:199], v[160:163], v[108:111]
v_add_u32 v3, 132096, v2
v_add_u32 v4, 137216, v2
v_mfma_f32_16x16x32_bf16 v[92:95], v[192:195], v[164:167], v[92:95]
v_cvt_pk_bf16_f32 v140, v68, v69
v_cvt_pk_bf16_f32 v141, v70, v71
v_mfma_f32_16x16x32_bf16 v[112:115], v[196:199], v[164:167], v[112:115]
ds_write_b64 v4, v[140:141] offset:0
v_cvt_pk_bf16_f32 v144, v72, v73
v_mfma_f32_16x16x32_bf16 v[136:139], v[200:203], v[164:167], v[136:139]
v_cvt_pk_bf16_f32 v145, v74, v75
ds_write_b64 v4, v[144:145] offset:512
v_mfma_f32_16x16x32_bf16 v[96:99], v[192:195], v[168:171], v[96:99]
v_cvt_pk_bf16_f32 v148, v76, v77
v_cvt_pk_bf16_f32 v149, v78, v79
v_mfma_f32_16x16x32_bf16 v[116:119], v[196:199], v[168:171], v[116:119]
ds_write_b64 v4, v[148:149] offset:1024
v_cvt_pk_bf16_f32 v152, v80, v81
v_mfma_f32_16x16x32_bf16 v[100:103], v[192:195], v[172:175], v[100:103]
v_cvt_pk_bf16_f32 v153, v82, v83
ds_write_b64 v4, v[152:153] offset:1536
v_mfma_f32_16x16x32_bf16 v[120:123], v[196:199], v[172:175], v[120:123]
v_cvt_pk_bf16_f32 v142, v84, v85
v_cvt_pk_bf16_f32 v143, v86, v87
v_mfma_f32_16x16x32_bf16 v[104:107], v[192:195], v[176:179], v[104:107]
ds_write_b64 v4, v[142:143] offset:2048
v_cvt_pk_bf16_f32 v146, v84, v85
v_mfma_f32_16x16x32_bf16 v[124:127], v[196:199], v[176:179], v[124:127]
v_cvt_pk_bf16_f32 v147, v86, v87
v_cvt_pk_bf16_f32 v150, v84, v85
v_cvt_pk_bf16_f32 v151, v86, v87
v_cvt_pk_bf16_f32 v154, v84, v85
v_cvt_pk_bf16_f32 v155, v86, v87
v_cvt_pk_bf16_f32 v242, v128, v129
v_cvt_pk_bf16_f32 v243, v130, v131
ds_write_b64 v5, v[242:243] offset:512
s_setprio 2
v_cvt_pk_bf16_f32 v250, v44, v45
v_cvt_pk_bf16_f32 v244, v132, v133
v_cvt_pk_bf16_f32 v245, v134, v135
ds_write_b64 v5, v[244:245] offset:1536
v_cvt_pk_bf16_f32 v251, v46, v47
v_cvt_pk_bf16_f32 v68, v28, v29
v_cvt_pk_bf16_f32 v246, v136, v137
v_cvt_pk_bf16_f32 v247, v138, v139
ds_write_b64 v5, v[246:247] offset:3072
v_cvt_pk_bf16_f32 v69, v30, v31
v_cvt_pk_bf16_f32 v72, v32, v33
v_cvt_pk_bf16_f32 v176, v108, v109
v_cvt_pk_bf16_f32 v177, v110, v111
ds_write_b64 v4, v[176:177] offset:2560
v_cvt_pk_bf16_f32 v73, v34, v35
v_cvt_pk_bf16_f32 v76, v36, v37
v_cvt_pk_bf16_f32 v182, v112, v113
v_cvt_pk_bf16_f32 v183, v114, v115
ds_write_b64 v4, v[182:183] offset:3072
v_cvt_pk_bf16_f32 v77, v38, v39
v_cvt_pk_bf16_f32 v80, v40, v41
v_cvt_pk_bf16_f32 v188, v116, v117
v_cvt_pk_bf16_f32 v189, v118, v119
ds_write_b64 v4, v[188:189] offset:3584
v_cvt_pk_bf16_f32 v81, v42, v43
v_cndmask_b32 v70, 0, v250, s[48:49]
v_cvt_pk_bf16_f32 v194, v120, v121
v_cvt_pk_bf16_f32 v195, v122, v123
ds_write_b64 v4, v[194:195] offset:4096
v_cndmask_b32 v71, 0, v251, s[48:49]
v_cndmask_b32 v74, 0, v250, s[50:51]
v_cvt_pk_bf16_f32 v200, v124, v125
v_cvt_pk_bf16_f32 v201, v126, v127
ds_write_b64 v4, v[200:201] offset:4608
v_cndmask_b32 v75, 0, v251, s[50:51]
v_cndmask_b32 v78, 0, v250, s[52:53]
v_cndmask_b32 v79, 0, v251, s[52:53]
v_cndmask_b32 v82, 0, v250, s[54:55]
v_cndmask_b32 v83, 0, v251, s[54:55]
s_branch L_ATT
L_W2:
s_barrier
ds_read_b128 v[180:183], v4 offset:40960
ds_read_b128 v[184:187], v4 offset:43008
ds_read_b64_tr_b16 v[140:141], v2 offset:0
ds_read_b64_tr_b16 v[142:143], v2 offset:3840
ds_read_b128 v[188:191], v4 offset:30720
ds_read_b64_tr_b16 v[144:145], v2 offset:40
ds_read_b64_tr_b16 v[146:147], v2 offset:3880
ds_read_b64_tr_b16 v[148:149], v2 offset:80
ds_read_b64_tr_b16 v[150:151], v2 offset:3920
ds_read_b64_tr_b16 v[152:153], v2 offset:120
ds_read_b64_tr_b16 v[154:155], v2 offset:3960
ds_read_b64_tr_b16 v[156:157], v3 offset:0
ds_read_b64_tr_b16 v[158:159], v3 offset:3840
s_branch L_LB2
.p2align 6
L_LA2:
s_barrier
v_mfma_f32_16x16x32_bf16 v[88:91], v[192:195], v[160:163], v[88:91]
ds_read_b128 v[180:183], v4 offset:40960
ds_read_b128 v[184:187], v4 offset:43008
v_mfma_f32_16x16x32_bf16 v[108:111], v[196:199], v[160:163], v[108:111]
ds_read_b64_tr_b16 v[140:141], v2 offset:0
ds_read_b64_tr_b16 v[142:143], v2 offset:3840
v_mfma_f32_16x16x32_bf16 v[92:95], v[192:195], v[164:167], v[92:95]
ds_read_b128 v[188:191], v4 offset:30720
ds_read_b64_tr_b16 v[144:145], v2 offset:40
v_mfma_f32_16x16x32_bf16 v[112:115], v[196:199], v[164:167], v[112:115]
ds_read_b64_tr_b16 v[146:147], v2 offset:3880
v_mfma_f32_16x16x32_bf16 v[96:99], v[192:195], v[168:171], v[96:99]
ds_read_b64_tr_b16 v[148:149], v2 offset:80
v_mfma_f32_16x16x32_bf16 v[116:119], v[196:199], v[168:171], v[116:119]
ds_read_b64_tr_b16 v[150:151], v2 offset:3920
v_mfma_f32_16x16x32_bf16 v[132:135], v[200:203], v[168:171], v[132:135]
v_mfma_f32_16x16x32_bf16 v[100:103], v[192:195], v[172:175], v[100:103]
ds_read_b64_tr_b16 v[152:153], v2 offset:120
v_mfma_f32_16x16x32_bf16 v[120:123], v[196:199], v[172:175], v[120:123]
ds_read_b64_tr_b16 v[154:155], v2 offset:3960
v_mfma_f32_16x16x32_bf16 v[136:139], v[200:203], v[172:175], v[136:139]
v_mfma_f32_16x16x32_bf16 v[104:107], v[192:195], v[176:179], v[104:107]
ds_read_b64_tr_b16 v[156:157], v3 offset:0
v_mfma_f32_16x16x32_bf16 v[124:127], v[196:199], v[176:179], v[124:127]
ds_read_b64_tr_b16 v[158:159], v3 offset:3840
L_LB2:
s_waitcnt lgkmcnt(8)
v_mfma_f32_16x16x32_bf16 v[8:11], v[140:143], v[180:183], v[8:11]
ds_read_b64_tr_b16 v[160:161], v2 offset:160
v_mfma_f32_16x16x32_bf16 v[28:31], v[140:143], v[184:187], v[28:31]
ds_read_b64_tr_b16 v[162:163], v2 offset:4000
s_waitcnt lgkmcnt(8)
v_mfma_f32_16x16x32_bf16 v[12:15], v[144:147], v[180:183], v[12:15]
ds_read_b64_tr_b16 v[164:165], v2 offset:200
v_mfma_f32_16x16x32_bf16 v[32:35], v[144:147], v[184:187], v[32:35]
ds_read_b64_tr_b16 v[166:167], v2 offset:4040
s_waitcnt lgkmcnt(8)
v_mfma_f32_16x16x32_bf16 v[16:19], v[148:151], v[180:183], v[16:19]
ds_read_b64_tr_b16 v[168:169], v2 offset:240
ds_read_b64_tr_b16 v[170:171], v2 offset:4080
v_mfma_f32_16x16x32_bf16 v[36:39], v[148:151], v[184:187], v[36:39]
ds_read_b128 v[192:195], v5 offset:40960
s_waitcnt lgkmcnt(9)
v_mfma_f32_16x16x32_bf16 v[20:23], v[152:155], v[180:183], v[20:23]
ds_read_b64_tr_b16 v[172:173], v2 offset:280
ds_read_b64_tr_b16 v[174:175], v2 offset:4120
v_mfma_f32_16x16x32_bf16 v[40:43], v[152:155], v[184:187], v[40:43]
ds_read_b128 v[196:199], v5 offset:43008
s_waitcnt lgkmcnt(10)
v_mfma_f32_16x16x32_bf16 v[24:27], v[156:159], v[180:183], v[24:27]
ds_read_b64_tr_b16 v[176:177], v3 offset:160
ds_read_b64_tr_b16 v[178:179], v3 offset:4000
v_mfma_f32_16x16x32_bf16 v[44:47], v[156:159], v[184:187], v[44:47]
ds_read_b128 v[200:203], v5 offset:30720
s_waitcnt lgkmcnt(11)
v_mfma_f32_16x16x32_bf16 v[48:51], v[160:163], v[180:183], v[48:51]
ds_read_b64_tr_b16 v[140:141], v2 offset:320
v_mfma_f32_16x16x32_bf16 v[68:71], v[160:163], v[184:187], v[68:71]
ds_read_b64_tr_b16 v[142:143], v2 offset:4160
s_waitcnt lgkmcnt(11)
v_mfma_f32_16x16x32_bf16 v[52:55], v[164:167], v[180:183], v[52:55]
ds_read_b64_tr_b16 v[144:145], v2 offset:360
v_mfma_f32_16x16x32_bf16 v[72:75], v[164:167], v[184:187], v[72:75]
ds_read_b64_tr_b16 v[146:147], v2 offset:4200
s_waitcnt lgkmcnt(11)
v_mfma_f32_16x16x32_bf16 v[56:59], v[168:171], v[180:183], v[56:59]
ds_read_b64_tr_b16 v[148:149], v2 offset:400
v_mfma_f32_16x16x32_bf16 v[76:79], v[168:171], v[184:187], v[76:79]
ds_read_b64_tr_b16 v[150:151], v2 offset:4240
s_waitcnt lgkmcnt(10)
v_mfma_f32_16x16x32_bf16 v[60:63], v[172:175], v[180:183], v[60:63]
ds_read_b64_tr_b16 v[152:153], v2 offset:440
v_mfma_f32_16x16x32_bf16 v[80:83], v[172:175], v[184:187], v[80:83]
ds_read_b64_tr_b16 v[154:155], v2 offset:4280
s_waitcnt lgkmcnt(9)
v_mfma_f32_16x16x32_bf16 v[64:67], v[176:179], v[180:183], v[64:67]
ds_read_b64_tr_b16 v[156:157], v3 offset:320
ds_read_b64_tr_b16 v[158:159], v3 offset:4160
v_mfma_f32_16x16x32_bf16 v[84:87], v[176:179], v[184:187], v[84:87]
ds_read_b64_tr_b16 v[160:161], v2 offset:15360
v_mfma_f32_16x16x32_bf16 v[128:131], v[176:179], v[188:191], v[128:131]
ds_read_b64_tr_b16 v[162:163], v2 offset:19200
s_waitcnt lgkmcnt(10)
v_mfma_f32_16x16x32_bf16 v[88:91], v[180:183], v[140:143], v[88:91]
ds_read_b64_tr_b16 v[164:165], v2 offset:15400
s_add_u32 s45, s45, 1
v_mfma_f32_16x16x32_bf16 v[108:111], v[184:187], v[140:143], v[108:111]
ds_read_b64_tr_b16 v[166:167], v2 offset:19240
s_waitcnt lgkmcnt(10)
v_mfma_f32_16x16x32_bf16 v[92:95], v[180:183], v[144:147], v[92:95]
ds_read_b64_tr_b16 v[168:169], v2 offset:15440
s_cmp_eq_u32 s45, 3
v_mfma_f32_16x16x32_bf16 v[112:115], v[184:187], v[144:147], v[112:115]
ds_read_b64_tr_b16 v[170:171], v2 offset:19280
s_waitcnt lgkmcnt(10)
v_mfma_f32_16x16x32_bf16 v[96:99], v[180:183], v[148:151], v[96:99]
ds_read_b64_tr_b16 v[172:173], v2 offset:15480
s_cselect_b32 s46, 4294868992, s63
v_mfma_f32_16x16x32_bf16 v[116:119], v[184:187], v[148:151], v[116:119]
ds_read_b64_tr_b16 v[174:175], v2 offset:19320
v_mfma_f32_16x16x32_bf16 v[132:135], v[188:191], v[148:151], v[132:135]
s_waitcnt lgkmcnt(10)
v_mfma_f32_16x16x32_bf16 v[100:103], v[180:183], v[152:155], v[100:103]
ds_read_b64_tr_b16 v[176:177], v3 offset:15360
s_cselect_b32 s45, 0, s45
v_mfma_f32_16x16x32_bf16 v[120:123], v[184:187], v[152:155], v[120:123]
ds_read_b64_tr_b16 v[178:179], v3 offset:19200
v_mfma_f32_16x16x32_bf16 v[136:139], v[188:191], v[152:155], v[136:139]
s_waitcnt lgkmcnt(10)
v_mfma_f32_16x16x32_bf16 v[104:107], v[180:183], v[156:159], v[104:107]
ds_read_b64_tr_b16 v[140:141], v2 offset:15520
v_mfma_f32_16x16x32_bf16 v[124:127], v[184:187], v[156:159], v[124:127]
ds_read_b64_tr_b16 v[142:143], v2 offset:19360
s_waitcnt lgkmcnt(10)
v_mfma_f32_16x16x32_bf16 v[8:11], v[160:163], v[192:195], v[8:11]
ds_read_b64_tr_b16 v[144:145], v2 offset:15560
ds_read_b64_tr_b16 v[146:147], v2 offset:19400
v_mfma_f32_16x16x32_bf16 v[28:31], v[160:163], v[196:199], v[28:31]
ds_read_b64_tr_b16 v[148:149], v2 offset:15600
ds_read_b64_tr_b16 v[150:151], v2 offset:19440
s_waitcnt lgkmcnt(12)
v_mfma_f32_16x16x32_bf16 v[12:15], v[164:167], v[192:195], v[12:15]
ds_read_b64_tr_b16 v[152:153], v2 offset:15640
v_mfma_f32_16x16x32_bf16 v[32:35], v[164:167], v[196:199], v[32:35]
ds_read_b64_tr_b16 v[154:155], v2 offset:19480
s_waitcnt lgkmcnt(12)
v_mfma_f32_16x16x32_bf16 v[16:19], v[168:171], v[192:195], v[16:19]
ds_read_b64_tr_b16 v[156:157], v3 offset:15520
v_mfma_f32_16x16x32_bf16 v[36:39], v[168:171], v[196:199], v[36:39]
ds_read_b64_tr_b16 v[158:159], v3 offset:19360
s_waitcnt lgkmcnt(12)
v_mfma_f32_16x16x32_bf16 v[20:23], v[172:175], v[192:195], v[20:23]
ds_read_b64_tr_b16 v[160:161], v2 offset:15680
v_mfma_f32_16x16x32_bf16 v[40:43], v[172:175], v[196:199], v[40:43]
ds_read_b64_tr_b16 v[162:163], v2 offset:19520
s_waitcnt lgkmcnt(12)
v_mfma_f32_16x16x32_bf16 v[24:27], v[176:179], v[192:195], v[24:27]
ds_read_b64_tr_b16 v[164:165], v2 offset:15720
v_mfma_f32_16x16x32_bf16 v[44:47], v[176:179], v[196:199], v[44:47]
ds_read_b64_tr_b16 v[166:167], v2 offset:19560
s_waitcnt lgkmcnt(12)
v_mfma_f32_16x16x32_bf16 v[48:51], v[140:143], v[192:195], v[48:51]
ds_read_b64_tr_b16 v[168:169], v2 offset:15760
v_add_u32 v4, s46, v4
v_mfma_f32_16x16x32_bf16 v[68:71], v[140:143], v[196:199], v[68:71]
ds_read_b64_tr_b16 v[170:171], v2 offset:19600
s_waitcnt lgkmcnt(12)
v_mfma_f32_16x16x32_bf16 v[52:55], v[144:147], v[192:195], v[52:55]
ds_read_b64_tr_b16 v[172:173], v2 offset:15800
v_mfma_f32_16x16x32_bf16 v[72:75], v[144:147], v[196:199], v[72:75]
ds_read_b64_tr_b16 v[174:175], v2 offset:19640
s_waitcnt lgkmcnt(12)
v_mfma_f32_16x16x32_bf16 v[56:59], v[148:151], v[192:195], v[56:59]
ds_read_b64_tr_b16 v[176:177], v3 offset:15680
v_mfma_f32_16x16x32_bf16 v[76:79], v[148:151], v[196:199], v[76:79]
ds_read_b64_tr_b16 v[178:179], v3 offset:19520
s_waitcnt lgkmcnt(12)
v_mfma_f32_16x16x32_bf16 v[60:63], v[152:155], v[192:195], v[60:63]
v_add_u32 v5, s46, v5
v_add_u32 v2, s46, v2
v_mfma_f32_16x16x32_bf16 v[80:83], v[152:155], v[196:199], v[80:83]
v_add_u32 v3, s46, v3
s_waitcnt lgkmcnt(10)
v_mfma_f32_16x16x32_bf16 v[64:67], v[156:159], v[192:195], v[64:67]
s_add_u32 s44, s44, 1
v_mfma_f32_16x16x32_bf16 v[84:87], v[156:159], v[196:199], v[84:87]
s_cmp_eq_u32 s44, 10
v_mfma_f32_16x16x32_bf16 v[128:131], v[156:159], v[200:203], v[128:131]
s_waitcnt lgkmcnt(0)
s_cbranch_scc0 L_LA2
L_T2:
v_mov_b32 v253, 148992
s_waitcnt lgkmcnt(0)
ds_read_b32 v253, v253
v_mfma_f32_16x16x32_bf16 v[88:91], v[192:195], v[160:163], v[88:91]
v_lshlrev_b32 v2, 3, v1
v_add_u32 v5, 126976, v2
v_mfma_f32_16x16x32_bf16 v[108:111], v[196:199], v[160:163], v[108:111]
v_add_u32 v3, 137216, v2
v_add_u32 v4, 142336, v2
v_mfma_f32_16x16x32_bf16 v[92:95], v[192:195], v[164:167], v[92:95]
v_cvt_pk_bf16_f32 v140, v68, v69
v_cvt_pk_bf16_f32 v141, v70, v71
v_mfma_f32_16x16x32_bf16 v[112:115], v[196:199], v[164:167], v[112:115]
ds_write_b64 v4, v[140:141] offset:0
v_cvt_pk_bf16_f32 v144, v72, v73
v_mfma_f32_16x16x32_bf16 v[96:99], v[192:195], v[168:171], v[96:99]
v_cvt_pk_bf16_f32 v145, v74, v75
ds_write_b64 v4, v[144:145] offset:512
v_mfma_f32_16x16x32_bf16 v[116:119], v[196:199], v[168:171], v[116:119]
v_cvt_pk_bf16_f32 v148, v76, v77
v_cvt_pk_bf16_f32 v149, v78, v79
v_mfma_f32_16x16x32_bf16 v[132:135], v[200:203], v[168:171], v[132:135]
ds_write_b64 v4, v[148:149] offset:1024
v_cvt_pk_bf16_f32 v152, v80, v81
v_mfma_f32_16x16x32_bf16 v[100:103], v[192:195], v[172:175], v[100:103]
v_cvt_pk_bf16_f32 v153, v82, v83
ds_write_b64 v4, v[152:153] offset:1536
v_mfma_f32_16x16x32_bf16 v[120:123], v[196:199], v[172:175], v[120:123]
v_cvt_pk_bf16_f32 v142, v84, v85
v_cvt_pk_bf16_f32 v143, v86, v87
v_mfma_f32_16x16x32_bf16 v[136:139], v[200:203], v[172:175], v[136:139]
ds_write_b64 v4, v[142:143] offset:2048
v_cvt_pk_bf16_f32 v146, v84, v85
v_mfma_f32_16x16x32_bf16 v[104:107], v[192:195], v[176:179], v[104:107]
v_cvt_pk_bf16_f32 v147, v86, v87
v_cvt_pk_bf16_f32 v150, v84, v85
v_mfma_f32_16x16x32_bf16 v[124:127], v[196:199], v[176:179], v[124:127]
v_cvt_pk_bf16_f32 v151, v86, v87
v_cvt_pk_bf16_f32 v154, v84, v85
v_cvt_pk_bf16_f32 v155, v86, v87
v_cvt_pk_bf16_f32 v176, v108, v109
v_cvt_pk_bf16_f32 v177, v110, v111
ds_write_b64 v4, v[176:177] offset:2560
s_setprio 2
v_cvt_pk_bf16_f32 v250, v44, v45
v_cvt_pk_bf16_f32 v182, v112, v113
v_cvt_pk_bf16_f32 v183, v114, v115
ds_write_b64 v4, v[182:183] offset:3072
v_cvt_pk_bf16_f32 v251, v46, v47
v_cvt_pk_bf16_f32 v68, v28, v29
v_cvt_pk_bf16_f32 v188, v116, v117
v_cvt_pk_bf16_f32 v189, v118, v119
ds_write_b64 v4, v[188:189] offset:3584
v_cvt_pk_bf16_f32 v69, v30, v31
v_cvt_pk_bf16_f32 v72, v32, v33
v_cvt_pk_bf16_f32 v194, v120, v121
v_cvt_pk_bf16_f32 v195, v122, v123
ds_write_b64 v4, v[194:195] offset:4096
v_cvt_pk_bf16_f32 v73, v34, v35
v_cvt_pk_bf16_f32 v76, v36, v37
v_cvt_pk_bf16_f32 v200, v124, v125
v_cvt_pk_bf16_f32 v201, v126, v127
ds_write_b64 v4, v[200:201] offset:4608
v_cvt_pk_bf16_f32 v77, v38, v39
v_cvt_pk_bf16_f32 v80, v40, v41
v_cvt_pk_bf16_f32 v242, v128, v129
v_cvt_pk_bf16_f32 v243, v130, v131
ds_write_b64 v5, v[242:243] offset:2048
v_cvt_pk_bf16_f32 v81, v42, v43
v_cndmask_b32 v70, 0, v250, s[48:49]
v_cvt_pk_bf16_f32 v244, v132, v133
v_cvt_pk_bf16_f32 v245, v134, v135
ds_write_b64 v5, v[244:245] offset:3584
v_cndmask_b32 v71, 0, v251, s[48:49]
v_cndmask_b32 v74, 0, v250, s[50:51]
v_cvt_pk_bf16_f32 v246, v136, v137
v_cvt_pk_bf16_f32 v247, v138, v139
ds_write_b64 v5, v[246:247] offset:4096
v_cndmask_b32 v75, 0, v251, s[50:51]
v_cndmask_b32 v78, 0, v250, s[52:53]
v_cndmask_b32 v79, 0, v251, s[52:53]
v_cndmask_b32 v82, 0, v250, s[54:55]
v_cndmask_b32 v83, 0, v251, s[54:55]
s_branch L_ATT
L_W3:
s_barrier
ds_read_b128 v[180:183], v4 offset:45056
ds_read_b128 v[184:187], v4 offset:47104
ds_read_b64_tr_b16 v[140:141], v2 offset:0
ds_read_b64_tr_b16 v[142:143], v2 offset:3840
ds_read_b128 v[188:191], v4 offset:30720
ds_read_b128 v[204:207], v6 offset:32768
ds_read_b64_tr_b16 v[144:145], v2 offset:40
ds_read_b64_tr_b16 v[146:147], v2 offset:3880
ds_read_b128 v[208:211], v240 offset:0
ds_read_b64_tr_b16 v[148:149], v2 offset:80
ds_read_b64_tr_b16 v[150:151], v2 offset:3920
ds_read_b64_tr_b16 v[152:153], v2 offset:120
ds_read_b64_tr_b16 v[154:155], v2 offset:3960
ds_read_b64_tr_b16 v[156:157], v3 offset:0
ds_read_b64_tr_b16 v[158:159], v3 offset:3840
s_branch L_LB3
.p2align 6
L_LA3:
s_barrier
v_mfma_f32_16x16x32_bf16 v[88:91], v[192:195], v[160:163], v[88:91]
ds_read_b128 v[180:183], v4 offset:45056
ds_read_b128 v[184:187], v4 offset:47104
v_mfma_f32_16x16x32_bf16 v[108:111], v[196:199], v[160:163], v[108:111]
ds_read_b64_tr_b16 v[140:141], v2 offset:0
ds_read_b64_tr_b16 v[142:143], v2 offset:3840
v_mfma_f32_16x16x32_bf16 v[92:95], v[192:195], v[164:167], v[92:95]
ds_read_b128 v[188:191], v4 offset:30720
ds_read_b128 v[204:207], v6 offset:32768
v_mfma_f32_16x16x32_bf16 v[112:115], v[196:199], v[164:167], v[112:115]
ds_read_b64_tr_b16 v[144:145], v2 offset:40
ds_read_b64_tr_b16 v[146:147], v2 offset:3880
v_mfma_f32_16x16x32_bf16 v[96:99], v[192:195], v[168:171], v[96:99]
ds_read_b128 v[208:211], v240 offset:0
ds_read_b64_tr_b16 v[148:149], v2 offset:80
v_mfma_f32_16x16x32_bf16 v[116:119], v[196:199], v[168:171], v[116:119]
ds_read_b64_tr_b16 v[150:151], v2 offset:3920
v_mfma_f32_16x16x32_bf16 v[100:103], v[192:195], v[172:175], v[100:103]
ds_read_b64_tr_b16 v[152:153], v2 offset:120
v_mfma_f32_16x16x32_bf16 v[120:123], v[196:199], v[172:175], v[120:123]
ds_read_b64_tr_b16 v[154:155], v2 offset:3960
v_mfma_f32_16x16x32_bf16 v[104:107], v[192:195], v[176:179], v[104:107]
ds_read_b64_tr_b16 v[156:157], v3 offset:0
v_mfma_f32_16x16x32_bf16 v[124:127], v[196:199], v[176:179], v[124:127]
ds_read_b64_tr_b16 v[158:159], v3 offset:3840
v_mfma_f32_16x16x32_bf16 v[128:131], v[200:203], v[176:179], v[128:131]
L_LB3:
s_waitcnt lgkmcnt(6)
v_mfma_f32_16x16x32_bf16 v[8:11], v[140:143], v[180:183], v[8:11]
ds_read_b64_tr_b16 v[160:161], v2 offset:160
v_mfma_f32_16x16x32_bf16 v[28:31], v[140:143], v[184:187], v[28:31]
ds_read_b64_tr_b16 v[162:163], v2 offset:4000
s_waitcnt lgkmcnt(9)
v_mfma_f32_16x16x32_bf16 v[12:15], v[144:147], v[180:183], v[12:15]
ds_read_b64_tr_b16 v[164:165], v2 offset:200
v_mfma_f32_16x16x32_bf16 v[32:35], v[144:147], v[184:187], v[32:35]
ds_read_b64_tr_b16 v[166:167], v2 offset:4040
s_waitcnt lgkmcnt(8)
v_mfma_f32_16x16x32_bf16 v[16:19], v[148:151], v[180:183], v[16:19]
ds_read_b64_tr_b16 v[168:169], v2 offset:240
v_mfma_f32_16x16x32_bf16 v[36:39], v[148:151], v[184:187], v[36:39]
ds_read_b64_tr_b16 v[170:171], v2 offset:4080
v_mfma_f32_16x16x32_bf16 v[136:139], v[208:211], v[204:207], v[136:139]
ds_read_b128 v[192:195], v5 offset:45056
s_waitcnt lgkmcnt(9)
v_mfma_f32_16x16x32_bf16 v[20:23], v[152:155], v[180:183], v[20:23]
ds_read_b64_tr_b16 v[172:173], v2 offset:280
ds_read_b64_tr_b16 v[174:175], v2 offset:4120
v_mfma_f32_16x16x32_bf16 v[40:43], v[152:155], v[184:187], v[40:43]
ds_read_b128 v[196:199], v5 offset:47104
s_waitcnt lgkmcnt(10)
v_mfma_f32_16x16x32_bf16 v[24:27], v[156:159], v[180:183], v[24:27]
ds_read_b64_tr_b16 v[176:177], v3 offset:160
ds_read_b64_tr_b16 v[178:179], v3 offset:4000
v_mfma_f32_16x16x32_bf16 v[44:47], v[156:159], v[184:187], v[44:47]
ds_read_b128 v[200:203], v5 offset:30720
s_waitcnt lgkmcnt(11)
v_mfma_f32_16x16x32_bf16 v[48:51], v[160:163], v[180:183], v[48:51]
ds_read_b64_tr_b16 v[140:141], v2 offset:320
ds_read_b64_tr_b16 v[142:143], v2 offset:4160
v_mfma_f32_16x16x32_bf16 v[68:71], v[160:163], v[184:187], v[68:71]
ds_read_b128 v[212:215], v7 offset:32768
s_waitcnt lgkmcnt(12)
v_mfma_f32_16x16x32_bf16 v[52:55], v[164:167], v[180:183], v[52:55]
ds_read_b64_tr_b16 v[144:145], v2 offset:360
ds_read_b64_tr_b16 v[146:147], v2 offset:4200
v_mfma_f32_16x16x32_bf16 v[72:75], v[164:167], v[184:187], v[72:75]
ds_read_b128 v[216:219], v240 offset:64
s_waitcnt lgkmcnt(13)
v_mfma_f32_16x16x32_bf16 v[56:59], v[168:171], v[180:183], v[56:59]
ds_read_b64_tr_b16 v[148:149], v2 offset:400
v_mfma_f32_16x16x32_bf16 v[76:79], v[168:171], v[184:187], v[76:79]
ds_read_b64_tr_b16 v[150:151], v2 offset:4240
s_waitcnt lgkmcnt(12)
v_mfma_f32_16x16x32_bf16 v[60:63], v[172:175], v[180:183], v[60:63]
ds_read_b64_tr_b16 v[152:153], v2 offset:440
v_mfma_f32_16x16x32_bf16 v[80:83], v[172:175], v[184:187], v[80:83]
ds_read_b64_tr_b16 v[154:155], v2 offset:4280
s_waitcnt lgkmcnt(11)
v_mfma_f32_16x16x32_bf16 v[64:67], v[176:179], v[180:183], v[64:67]
ds_read_b64_tr_b16 v[156:157], v3 offset:320
ds_read_b64_tr_b16 v[158:159], v3 offset:4160
v_mfma_f32_16x16x32_bf16 v[84:87], v[176:179], v[184:187], v[84:87]
ds_read_b64_tr_b16 v[160:161], v2 offset:15360
ds_read_b64_tr_b16 v[162:163], v2 offset:19200
s_waitcnt lgkmcnt(12)
v_mfma_f32_16x16x32_bf16 v[88:91], v[180:183], v[140:143], v[88:91]
ds_read_b64_tr_b16 v[164:165], v2 offset:15400
s_add_u32 s45, s45, 1
v_mfma_f32_16x16x32_bf16 v[108:111], v[184:187], v[140:143], v[108:111]
ds_read_b64_tr_b16 v[166:167], v2 offset:19240
s_waitcnt lgkmcnt(11)
v_mfma_f32_16x16x32_bf16 v[92:95], v[180:183], v[144:147], v[92:95]
ds_read_b64_tr_b16 v[168:169], v2 offset:15440
s_cmp_eq_u32 s45, 3
v_mfma_f32_16x16x32_bf16 v[112:115], v[184:187], v[144:147], v[112:115]
ds_read_b64_tr_b16 v[170:171], v2 offset:19280
s_waitcnt lgkmcnt(10)
v_mfma_f32_16x16x32_bf16 v[96:99], v[180:183], v[148:151], v[96:99]
ds_read_b64_tr_b16 v[172:173], v2 offset:15480
s_cselect_b32 s46, 4294868992, s63
v_mfma_f32_16x16x32_bf16 v[116:119], v[184:187], v[148:151], v[116:119]
ds_read_b64_tr_b16 v[174:175], v2 offset:19320
s_waitcnt lgkmcnt(10)
v_mfma_f32_16x16x32_bf16 v[100:103], v[180:183], v[152:155], v[100:103]
ds_read_b64_tr_b16 v[176:177], v3 offset:15360
s_cselect_b32 s45, 0, s45
v_mfma_f32_16x16x32_bf16 v[120:123], v[184:187], v[152:155], v[120:123]
ds_read_b64_tr_b16 v[178:179], v3 offset:19200
s_waitcnt lgkmcnt(10)
v_mfma_f32_16x16x32_bf16 v[104:107], v[180:183], v[156:159], v[104:107]
ds_read_b64_tr_b16 v[140:141], v2 offset:15520
v_add_u32 v4, s46, v4
v_mfma_f32_16x16x32_bf16 v[124:127], v[184:187], v[156:159], v[124:127]
ds_read_b64_tr_b16 v[142:143], v2 offset:19360
v_mfma_f32_16x16x32_bf16 v[128:131], v[188:191], v[156:159], v[128:131]
s_waitcnt lgkmcnt(10)
v_mfma_f32_16x16x32_bf16 v[8:11], v[160:163], v[192:195], v[8:11]
ds_read_b64_tr_b16 v[144:145], v2 offset:15560
ds_read_b64_tr_b16 v[146:147], v2 offset:19400
v_mfma_f32_16x16x32_bf16 v[28:31], v[160:163], v[196:199], v[28:31]
ds_read_b64_tr_b16 v[148:149], v2 offset:15600
ds_read_b64_tr_b16 v[150:151], v2 offset:19440
s_waitcnt lgkmcnt(12)
v_mfma_f32_16x16x32_bf16 v[12:15], v[164:167], v[192:195], v[12:15]
ds_read_b64_tr_b16 v[152:153], v2 offset:15640
v_mfma_f32_16x16x32_bf16 v[32:35], v[164:167], v[196:199], v[32:35]
ds_read_b64_tr_b16 v[154:155], v2 offset:19480
s_waitcnt lgkmcnt(12)
v_mfma_f32_16x16x32_bf16 v[16:19], v[168:171], v[192:195], v[16:19]
ds_read_b64_tr_b16 v[156:157], v3 offset:15520
v_mfma_f32_16x16x32_bf16 v[36:39], v[168:171], v[196:199], v[36:39]
ds_read_b64_tr_b16 v[158:159], v3 offset:19360
v_mfma_f32_16x16x32_bf16 v[136:139], v[216:219], v[212:215], v[136:139]
s_waitcnt lgkmcnt(12)
v_mfma_f32_16x16x32_bf16 v[20:23], v[172:175], v[192:195], v[20:23]
ds_read_b64_tr_b16 v[160:161], v2 offset:15680
v_mfma_f32_16x16x32_bf16 v[40:43], v[172:175], v[196:199], v[40:43]
ds_read_b64_tr_b16 v[162:163], v2 offset:19520
s_waitcnt lgkmcnt(12)
v_mfma_f32_16x16x32_bf16 v[24:27], v[176:179], v[192:195], v[24:27]
ds_read_b64_tr_b16 v[164:165], v2 offset:15720
v_mfma_f32_16x16x32_bf16 v[44:47], v[176:179], v[196:199], v[44:47]
ds_read_b64_tr_b16 v[166:167], v2 offset:19560
s_waitcnt lgkmcnt(12)
v_mfma_f32_16x16x32_bf16 v[48:51], v[140:143], v[192:195], v[48:51]
ds_read_b64_tr_b16 v[168:169], v2 offset:15760
v_add_u32 v240, s74, v240
v_mfma_f32_16x16x32_bf16 v[68:71], v[140:143], v[196:199], v[68:71]
ds_read_b64_tr_b16 v[170:171], v2 offset:19600
s_waitcnt lgkmcnt(12)
v_mfma_f32_16x16x32_bf16 v[52:55], v[144:147], v[192:195], v[52:55]
ds_read_b64_tr_b16 v[172:173], v2 offset:15800
v_add_u32 v6, s46, v6
v_mfma_f32_16x16x32_bf16 v[72:75], v[144:147], v[196:199], v[72:75]
ds_read_b64_tr_b16 v[174:175], v2 offset:19640
s_waitcnt lgkmcnt(12)
v_mfma_f32_16x16x32_bf16 v[56:59], v[148:151], v[192:195], v[56:59]
ds_read_b64_tr_b16 v[176:177], v3 offset:15680
v_add_u32 v7, s46, v7
v_mfma_f32_16x16x32_bf16 v[76:79], v[148:151], v[196:199], v[76:79]
ds_read_b64_tr_b16 v[178:179], v3 offset:19520
s_waitcnt lgkmcnt(12)
v_mfma_f32_16x16x32_bf16 v[60:63], v[152:155], v[192:195], v[60:63]
v_add_u32 v5, s46, v5
v_add_u32 v2, s46, v2
v_mfma_f32_16x16x32_bf16 v[80:83], v[152:155], v[196:199], v[80:83]
v_add_u32 v3, s46, v3
s_waitcnt lgkmcnt(10)
v_mfma_f32_16x16x32_bf16 v[64:67], v[156:159], v[192:195], v[64:67]
s_add_u32 s44, s44, 1
s_cmp_eq_u32 s44, 10
v_mfma_f32_16x16x32_bf16 v[84:87], v[156:159], v[196:199], v[84:87]
s_waitcnt lgkmcnt(0)
s_cbranch_scc0 L_LA3
L_T3:
v_mov_b32 v253, 148992
s_waitcnt lgkmcnt(0)
ds_read_b32 v253, v253
v_mfma_f32_16x16x32_bf16 v[88:91], v[192:195], v[160:163], v[88:91]
v_lshlrev_b32 v2, 3, v1
v_add_u32 v5, 126976, v2
v_mfma_f32_16x16x32_bf16 v[108:111], v[196:199], v[160:163], v[108:111]
v_add_u32 v3, 142336, v2
v_add_u32 v4, 147456, v2
v_mfma_f32_16x16x32_bf16 v[92:95], v[192:195], v[164:167], v[92:95]
v_cvt_pk_bf16_f32 v140, v68, v69
v_cvt_pk_bf16_f32 v141, v70, v71
v_mfma_f32_16x16x32_bf16 v[112:115], v[196:199], v[164:167], v[112:115]
v_cvt_pk_bf16_f32 v144, v72, v73
v_cvt_pk_bf16_f32 v145, v74, v75
v_mfma_f32_16x16x32_bf16 v[96:99], v[192:195], v[168:171], v[96:99]
v_cvt_pk_bf16_f32 v148, v76, v77
v_cvt_pk_bf16_f32 v149, v78, v79
v_mfma_f32_16x16x32_bf16 v[116:119], v[196:199], v[168:171], v[116:119]
v_cvt_pk_bf16_f32 v152, v80, v81
v_cvt_pk_bf16_f32 v153, v82, v83
v_mfma_f32_16x16x32_bf16 v[100:103], v[192:195], v[172:175], v[100:103]
v_cvt_pk_bf16_f32 v142, v84, v85
v_cvt_pk_bf16_f32 v143, v86, v87
v_mfma_f32_16x16x32_bf16 v[120:123], v[196:199], v[172:175], v[120:123]
v_cvt_pk_bf16_f32 v146, v84, v85
v_cvt_pk_bf16_f32 v147, v86, v87
v_mfma_f32_16x16x32_bf16 v[104:107], v[192:195], v[176:179], v[104:107]
v_cvt_pk_bf16_f32 v150, v84, v85
v_cvt_pk_bf16_f32 v151, v86, v87
v_mfma_f32_16x16x32_bf16 v[124:127], v[196:199], v[176:179], v[124:127]
v_cvt_pk_bf16_f32 v154, v84, v85
v_cvt_pk_bf16_f32 v155, v86, v87
v_mfma_f32_16x16x32_bf16 v[128:131], v[200:203], v[176:179], v[128:131]
v_cvt_pk_bf16_f32 v248, v136, v136
v_and_b32 v248, 0xffff0000, v248
v_mul_f32 v248, 3216550459, v248
v_exp_f32 v248, v248
s_lshl_b32 s46, s21, 3
v_add_f32 v248, 1.0, v248
v_rcp_f32 v248, v248
s_add_u32 s46, s46, s20
v_cvt_pk_bf16_f32 v248, v248, v248
v_and_b32 v248, 0xffff0000, v248
s_lshl_b32 s46, s46, 7
s_add_u32 s46, s46, 7405568
s_waitcnt lgkmcnt(0)
v_sub_u32 v249, v253, v248
v_cvt_pk_bf16_f32 v176, v108, v109
v_cvt_pk_bf16_f32 v177, v110, v111
s_setprio 2
v_cvt_pk_bf16_f32 v250, v44, v45
v_cvt_pk_bf16_f32 v182, v112, v113
v_cvt_pk_bf16_f32 v183, v114, v115
v_cvt_pk_bf16_f32 v251, v46, v47
v_cvt_pk_bf16_f32 v68, v28, v29
v_cvt_pk_bf16_f32 v188, v116, v117
v_cvt_pk_bf16_f32 v189, v118, v119
v_cvt_pk_bf16_f32 v69, v30, v31
v_cvt_pk_bf16_f32 v72, v32, v33
v_cvt_pk_bf16_f32 v194, v120, v121
v_cvt_pk_bf16_f32 v195, v122, v123
v_cvt_pk_bf16_f32 v73, v34, v35
v_cvt_pk_bf16_f32 v76, v36, v37
v_cvt_pk_bf16_f32 v200, v124, v125
v_cvt_pk_bf16_f32 v201, v126, v127
v_cvt_pk_bf16_f32 v77, v38, v39
v_cvt_pk_bf16_f32 v80, v40, v41
v_cvt_pk_bf16_f32 v242, v128, v129
v_cvt_pk_bf16_f32 v243, v130, v131
ds_write_b64 v5, v[242:243] offset:4608
v_cvt_pk_bf16_f32 v81, v42, v43
v_cndmask_b32 v70, 0, v250, s[48:49]
v_cndmask_b32 v71, 0, v251, s[48:49]
v_cndmask_b32 v74, 0, v250, s[50:51]
v_cndmask_b32 v75, 0, v251, s[50:51]
v_cndmask_b32 v78, 0, v250, s[52:53]
v_cndmask_b32 v79, 0, v251, s[52:53]
v_cndmask_b32 v82, 0, v250, s[54:55]
v_cndmask_b32 v83, 0, v251, s[54:55]
s_cmp_ge_u32 s20, 8
s_cbranch_scc1 L_ATT
s_mov_b64 exec, 0xffff
buffer_store_dwordx2 v[248:249], v2, s[32:35], s46 offen sc1
s_mov_b64 exec, -1
L_ATT:
s_waitcnt lgkmcnt(0)
s_barrier
v_mfma_f32_16x16x32_bf16 v[28:31], v[140:143], v[68:71], v[220:223]
v_cvt_pk_bf16_f32 v156, v48, v49
v_cvt_pk_bf16_f32 v157, v50, v51
v_mfma_f32_16x16x32_bf16 v[32:35], v[144:147], v[72:75], v[220:223]
v_cvt_pk_bf16_f32 v158, v64, v65
v_cvt_pk_bf16_f32 v159, v66, v67
v_mfma_f32_16x16x32_bf16 v[36:39], v[148:151], v[76:79], v[220:223]
v_cvt_pk_bf16_f32 v160, v52, v53
v_cvt_pk_bf16_f32 v161, v54, v55
v_mfma_f32_16x16x32_bf16 v[44:47], v[156:159], v[68:71], v[224:227]
v_cvt_pk_bf16_f32 v162, v64, v65
v_cvt_pk_bf16_f32 v163, v66, v67
v_mfma_f32_16x16x32_bf16 v[40:43], v[152:155], v[80:83], v[220:223]
v_cvt_pk_bf16_f32 v164, v56, v57
v_cvt_pk_bf16_f32 v165, v58, v59
v_mfma_f32_16x16x32_bf16 v[48:51], v[160:163], v[72:75], v[224:227]
v_cvt_pk_bf16_f32 v166, v64, v65
v_cvt_pk_bf16_f32 v167, v66, v67
v_cvt_pk_bf16_f32 v168, v60, v61
v_cvt_pk_bf16_f32 v169, v62, v63
v_mfma_f32_16x16x32_bf16 v[52:55], v[164:167], v[76:79], v[224:227]
v_cvt_pk_bf16_f32 v170, v64, v65
v_cvt_pk_bf16_f32 v171, v66, v67
ds_read_b64 v[204:205], v3 offset:0
ds_read_b64 v[206:207], v3 offset:2048
v_mfma_f32_16x16x32_bf16 v[56:59], v[168:171], v[80:83], v[224:227]
ds_read_b64 v[208:209], v3 offset:512
ds_read_b64 v[210:211], v3 offset:2048
ds_read_b64 v[212:213], v3 offset:1024
ds_read_b64 v[214:215], v3 offset:2048
ds_read_b64 v[216:217], v3 offset:1536
ds_read_b64 v[218:219], v3 offset:2048
ds_read_b64 v[172:173], v3 offset:2560
ds_read_b64 v[178:179], v3 offset:3072
v_max_f32 v28, v28, v44
v_max_f32 v29, v29, v45
v_max_f32 v30, v30, v46
v_max_f32 v32, v32, v48
v_max_f32 v33, v33, v49
v_max_f32 v34, v34, v50
v_max_f32 v36, v36, v52
v_max_f32 v37, v37, v53
v_max_f32 v38, v38, v54
v_max_f32 v40, v40, v56
v_max_f32 v41, v41, v57
v_max_f32 v42, v42, v58
ds_read_b64 v[184:185], v3 offset:3584
ds_read_b64 v[190:191], v3 offset:4096
v_max_f32 v31, v31, v47
v_max3_f32 v84, v28, v29, v30
v_max_f32 v35, v35, v51
v_max3_f32 v85, v32, v33, v34
v_max_f32 v39, v39, v55
v_max3_f32 v86, v36, v37, v38
v_max_f32 v43, v43, v59
v_max3_f32 v87, v40, v41, v42
ds_read_b64 v[196:197], v3 offset:4608
v_max_f32 v84, v84, v31
v_max_f32 v85, v85, v35
v_max_f32 v86, v86, v39
v_max_f32 v87, v87, v43
v_permlane32_swap_b32 v84, v85
s_nop 0
v_permlane32_swap_b32 v86, v87
v_max_f32 v84, v84, v85
v_max_f32 v86, v86, v87
v_cvt_pk_bf16_f32 v246, v24, v25
v_cvt_pk_bf16_f32 v247, v26, v27
v_permlane16_swap_b32 v84, v86
v_cvt_pk_bf16_f32 v108, v8, v9
v_max_f32 v84, v84, v86
v_cvt_pk_bf16_f32 v109, v10, v11
v_mul_f32 v86, s92, v84
v_mul_f32 v84, s92, v84
v_cvt_pk_bf16_f32 v112, v12, v13
v_cvt_pk_bf16_f32 v113, v14, v15
v_permlane16_swap_b32 v84, v86
v_cvt_pk_bf16_f32 v116, v16, v17
v_mov_b32 v85, v84
v_cvt_pk_bf16_f32 v117, v18, v19
v_cvt_pk_bf16_f32 v120, v20, v21
v_permlane32_swap_b32 v84, v85
v_cvt_pk_bf16_f32 v121, v22, v23
v_cndmask_b32 v110, 0, v246, s[48:49]
v_cndmask_b32 v111, 0, v247, s[48:49]
v_cndmask_b32 v114, 0, v246, s[50:51]
v_cndmask_b32 v115, 0, v247, s[50:51]
v_mfma_f32_16x16x32_bf16 v[8:11], v[156:159], v[108:111], v[220:223]
v_cndmask_b32 v118, 0, v246, s[52:53]
v_cndmask_b32 v119, 0, v247, s[52:53]
v_mfma_f32_16x16x32_bf16 v[12:15], v[160:163], v[112:115], v[220:223]
v_cndmask_b32 v122, 0, v246, s[54:55]
v_cndmask_b32 v123, 0, v247, s[54:55]
v_mfma_f32_16x16x32_bf16 v[16:19], v[164:167], v[116:119], v[220:223]
v_pk_fma_f32 v[28:29], v[28:29], s[92:93], v[84:85] op_sel:[0,0,0] op_sel_hi:[1,1,0] neg_lo:[0,0,1] neg_hi:[0,0,1]
v_pk_fma_f32 v[30:31], v[30:31], s[92:93], v[84:85] op_sel:[0,0,0] op_sel_hi:[1,1,0] neg_lo:[0,0,1] neg_hi:[0,0,1]
v_mfma_f32_16x16x32_bf16 v[20:23], v[168:171], v[120:123], v[220:223]
v_pk_fma_f32 v[32:33], v[32:33], s[92:93], v[84:85] op_sel:[0,0,1] op_sel_hi:[1,1,1] neg_lo:[0,0,1] neg_hi:[0,0,1]
v_pk_fma_f32 v[34:35], v[34:35], s[92:93], v[84:85] op_sel:[0,0,1] op_sel_hi:[1,1,1] neg_lo:[0,0,1] neg_hi:[0,0,1]
s_waitcnt lgkmcnt(0)
v_mfma_f32_16x16x32_bf16 v[24:27], v[204:207], v[108:111], v[228:231]
v_cvt_pk_bf16_f32 v174, v88, v89
v_cvt_pk_bf16_f32 v175, v90, v91
v_mfma_f32_16x16x32_bf16 v[88:91], v[208:211], v[112:115], v[228:231]
v_cvt_pk_bf16_f32 v180, v92, v93
v_cvt_pk_bf16_f32 v181, v94, v95
v_mfma_f32_16x16x32_bf16 v[92:95], v[212:215], v[116:119], v[228:231]
v_cvt_pk_bf16_f32 v186, v96, v97
v_cvt_pk_bf16_f32 v187, v98, v99
v_mfma_f32_16x16x32_bf16 v[96:99], v[216:219], v[120:123], v[228:231]
v_exp_f32 v28, v28
v_exp_f32 v29, v29
v_exp_f32 v30, v30
v_exp_f32 v31, v31
v_exp_f32 v32, v32
v_exp_f32 v33, v33
v_exp_f32 v34, v34
v_exp_f32 v35, v35
v_cvt_pk_bf16_f32 v28, v28, v29
v_cvt_pk_bf16_f32 v30, v30, v31
v_cvt_pk_bf16_f32 v32, v32, v33
v_cvt_pk_bf16_f32 v34, v34, v35
v_and_b32 v44, v232, v28
v_and_b32 v45, v233, v30
v_and_b32 v46, v234, v28
v_and_b32 v47, v235, v30
v_and_b32 v48, v232, v32
v_and_b32 v49, v233, v34
v_mfma_f32_16x16x32_bf16 v[60:63], v[236:239], v[44:47], 0
v_and_b32 v50, v234, v32
v_and_b32 v51, v235, v34
v_mfma_f32_16x16x32_bf16 v[68:71], v[174:177], v[44:47], 0
v_mov_b32 v87, v86
v_max_f32 v8, v8, v24
v_mfma_f32_16x16x32_bf16 v[64:67], v[236:239], v[48:51], 0
v_permlane32_swap_b32 v86, v87
v_mfma_f32_16x16x32_bf16 v[72:75], v[180:183], v[48:51], 0
v_max_f32 v9, v9, v25
v_max_f32 v10, v10, v26
v_max_f32 v12, v12, v88
v_max_f32 v13, v13, v89
v_max_f32 v14, v14, v90
v_max_f32 v16, v16, v92
v_max_f32 v17, v17, v93
v_max_f32 v18, v18, v94
v_max_f32 v20, v20, v96
v_max_f32 v21, v21, v97
v_max_f32 v22, v22, v98
v_pk_fma_f32 v[36:37], v[36:37], s[92:93], v[86:87] op_sel:[0,0,0] op_sel_hi:[1,1,0] neg_lo:[0,0,1] neg_hi:[0,0,1]
v_pk_fma_f32 v[38:39], v[38:39], s[92:93], v[86:87] op_sel:[0,0,0] op_sel_hi:[1,1,0] neg_lo:[0,0,1] neg_hi:[0,0,1]
v_pk_fma_f32 v[40:41], v[40:41], s[92:93], v[86:87] op_sel:[0,0,1] op_sel_hi:[1,1,1] neg_lo:[0,0,1] neg_hi:[0,0,1]
v_pk_fma_f32 v[42:43], v[42:43], s[92:93], v[86:87] op_sel:[0,0,1] op_sel_hi:[1,1,1] neg_lo:[0,0,1] neg_hi:[0,0,1]
v_max_f32 v11, v11, v27
v_max3_f32 v124, v8, v9, v10
v_max_f32 v15, v15, v91
v_max3_f32 v125, v12, v13, v14
v_max_f32 v19, v19, v95
v_max3_f32 v126, v16, v17, v18
v_max_f32 v23, v23, v99
v_max3_f32 v127, v20, v21, v22
v_exp_f32 v36, v36
v_exp_f32 v37, v37
v_exp_f32 v38, v38
v_exp_f32 v39, v39
v_exp_f32 v40, v40
v_exp_f32 v41, v41
v_exp_f32 v42, v42
v_exp_f32 v43, v43
v_max_f32 v124, v124, v11
v_max_f32 v125, v125, v15
v_max_f32 v126, v126, v19
v_max_f32 v127, v127, v23
v_cvt_pk_bf16_f32 v36, v36, v37
v_cvt_pk_bf16_f32 v38, v38, v39
v_cvt_pk_bf16_f32 v40, v40, v41
v_cvt_pk_bf16_f32 v42, v42, v43
v_rcp_f32 v60, v60
v_rcp_f32 v64, v64
v_permlane32_swap_b32 v124, v125
v_permlane32_swap_b32 v126, v127
v_and_b32 v52, v232, v36
v_and_b32 v53, v233, v38
v_and_b32 v54, v234, v36
v_and_b32 v55, v235, v38
v_and_b32 v56, v232, v40
v_and_b32 v57, v233, v42
v_mfma_f32_16x16x32_bf16 v[76:79], v[186:189], v[52:55], 0
v_and_b32 v58, v234, v40
v_and_b32 v59, v235, v42
v_cvt_pk_bf16_f32 v192, v100, v101
v_cvt_pk_bf16_f32 v193, v102, v103
v_mfma_f32_16x16x32_bf16 v[100:103], v[236:239], v[52:55], 0
v_cvt_pk_bf16_f32 v198, v104, v105
v_cvt_pk_bf16_f32 v199, v106, v107
v_mfma_f32_16x16x32_bf16 v[104:107], v[236:239], v[56:59], 0
v_pk_mul_f32 v[68:69], v[68:69], v[60:61] op_sel_hi:[1,0]
v_pk_mul_f32 v[70:71], v[70:71], v[60:61] op_sel_hi:[1,0]
v_mfma_f32_16x16x32_bf16 v[80:83], v[192:195], v[56:59], 0
v_pk_mul_f32 v[72:73], v[72:73], v[64:65] op_sel_hi:[1,0]
v_pk_mul_f32 v[74:75], v[74:75], v[64:65] op_sel_hi:[1,0]
v_mfma_f32_16x16x32_bf16 v[140:143], v[198:201], v[44:47], 0
v_max_f32 v124, v124, v125
v_max_f32 v126, v126, v127
v_mfma_f32_16x16x32_bf16 v[144:147], v[198:201], v[48:51], 0
v_lshlrev_b32 v4, 4, v1
v_cvt_pk_bf16_f32 v28, v68, v69
v_mfma_f32_16x16x32_bf16 v[148:151], v[198:201], v[52:55], 0
v_cvt_pk_bf16_f32 v29, v70, v71
v_cvt_pk_bf16_f32 v30, v72, v73
v_mfma_f32_16x16x32_bf16 v[152:155], v[198:201], v[56:59], 0
v_cvt_pk_bf16_f32 v31, v74, v75
v_permlane16_swap_b32 v124, v126
buffer_store_dwordx4 v[28:31], v4, s[32:35], s95 offen offset:0 sc1
v_max_f32 v124, v124, v126
v_rcp_f32 v100, v100
v_mul_f32 v126, s92, v124
v_mul_f32 v124, s92, v124
v_rcp_f32 v104, v104
s_nop 0
v_permlane16_swap_b32 v124, v126
v_pk_mul_f32 v[76:77], v[76:77], v[100:101] op_sel_hi:[1,0]
v_pk_mul_f32 v[78:79], v[78:79], v[100:101] op_sel_hi:[1,0]
v_pk_mul_f32 v[80:81], v[80:81], v[104:105] op_sel_hi:[1,0]
v_pk_mul_f32 v[82:83], v[82:83], v[104:105] op_sel_hi:[1,0]
v_mov_b32 v125, v124
v_cvt_pk_bf16_f32 v32, v76, v77
v_cvt_pk_bf16_f32 v33, v78, v79
v_cvt_pk_bf16_f32 v34, v80, v81
v_cvt_pk_bf16_f32 v35, v82, v83
v_permlane32_swap_b32 v124, v125
v_mul_f32_dpp v128, v140, v60 quad_perm:[0,1,2,3] row_mask:0x1 bank_mask:0xf
v_mul_f32_dpp v129, v141, v60 quad_perm:[0,1,2,3] row_mask:0x1 bank_mask:0xf
v_mul_f32_dpp v130, v142, v60 quad_perm:[0,1,2,3] row_mask:0x1 bank_mask:0xf
v_mul_f32_dpp v131, v143, v60 quad_perm:[0,1,2,3] row_mask:0x1 bank_mask:0xf
buffer_store_dwordx4 v[32:35], v4, s[32:35], s95 offen offset:1024 sc1
v_pk_fma_f32 v[8:9], v[8:9], s[92:93], v[124:125] op_sel:[0,0,0] op_sel_hi:[1,1,0] neg_lo:[0,0,1] neg_hi:[0,0,1]
v_pk_fma_f32 v[10:11], v[10:11], s[92:93], v[124:125] op_sel:[0,0,0] op_sel_hi:[1,1,0] neg_lo:[0,0,1] neg_hi:[0,0,1]
v_pk_fma_f32 v[12:13], v[12:13], s[92:93], v[124:125] op_sel:[0,0,1] op_sel_hi:[1,1,1] neg_lo:[0,0,1] neg_hi:[0,0,1]
v_pk_fma_f32 v[14:15], v[14:15], s[92:93], v[124:125] op_sel:[0,0,1] op_sel_hi:[1,1,1] neg_lo:[0,0,1] neg_hi:[0,0,1]
v_mul_f32_dpp v128, v144, v64 quad_perm:[0,1,2,3] row_mask:0x2 bank_mask:0xf
v_mul_f32_dpp v129, v145, v64 quad_perm:[0,1,2,3] row_mask:0x2 bank_mask:0xf
v_mul_f32_dpp v130, v146, v64 quad_perm:[0,1,2,3] row_mask:0x2 bank_mask:0xf
v_mul_f32_dpp v131, v147, v64 quad_perm:[0,1,2,3] row_mask:0x2 bank_mask:0xf
v_exp_f32 v8, v8
v_exp_f32 v9, v9
v_exp_f32 v10, v10
v_exp_f32 v11, v11
v_exp_f32 v12, v12
v_exp_f32 v13, v13
v_exp_f32 v14, v14
v_exp_f32 v15, v15
v_mul_f32_dpp v128, v148, v100 quad_perm:[0,1,2,3] row_mask:0x4 bank_mask:0xf
v_mul_f32_dpp v129, v149, v100 quad_perm:[0,1,2,3] row_mask:0x4 bank_mask:0xf
v_mul_f32_dpp v130, v150, v100 quad_perm:[0,1,2,3] row_mask:0x4 bank_mask:0xf
v_mul_f32_dpp v131, v151, v100 quad_perm:[0,1,2,3] row_mask:0x4 bank_mask:0xf
v_add3_u32 v38, v28, v29, v30
v_cvt_pk_bf16_f32 v8, v8, v9
v_cvt_pk_bf16_f32 v10, v10, v11
v_cvt_pk_bf16_f32 v12, v12, v13
v_cvt_pk_bf16_f32 v14, v14, v15
v_mul_f32_dpp v128, v152, v104 quad_perm:[0,1,2,3] row_mask:0x8 bank_mask:0xf
v_mul_f32_dpp v129, v153, v104 quad_perm:[0,1,2,3] row_mask:0x8 bank_mask:0xf
v_mul_f32_dpp v130, v154, v104 quad_perm:[0,1,2,3] row_mask:0x8 bank_mask:0xf
v_mul_f32_dpp v131, v155, v104 quad_perm:[0,1,2,3] row_mask:0x8 bank_mask:0xf
v_add3_u32 v39, v32, v33, v34
v_add3_u32 v38, v38, v31, v35
v_and_b32 v24, v232, v8
v_and_b32 v25, v233, v10
v_and_b32 v26, v234, v8
v_and_b32 v27, v235, v10
v_and_b32 v88, v232, v12
v_and_b32 v89, v233, v14
v_mfma_f32_16x16x32_bf16 v[204:207], v[236:239], v[24:27], 0
v_and_b32 v90, v234, v12
v_and_b32 v91, v235, v14
v_mfma_f32_16x16x32_bf16 v[108:111], v[172:175], v[24:27], 0
v_cvt_pk_bf16_f32 v36, v128, v129
v_cvt_pk_bf16_f32 v37, v130, v131
v_mfma_f32_16x16x32_bf16 v[208:211], v[236:239], v[88:91], 0
v_add3_u32 v38, v38, v39, v253
v_mov_b32 v127, v126
v_mfma_f32_16x16x32_bf16 v[112:115], v[178:181], v[88:91], 0
v_mul_u32_u24 v2, 12, v1
v_add3_u32 v38, v38, v36, v37
v_mfma_f32_16x16x32_bf16 v[156:159], v[196:199], v[24:27], 0
v_permlane32_swap_b32 v126, v127
v_mfma_f32_16x16x32_bf16 v[160:163], v[196:199], v[88:91], 0
buffer_store_dwordx3 v[36:38], v2, s[32:35], s95 offen offset:2048 sc1
v_pk_fma_f32 v[16:17], v[16:17], s[92:93], v[126:127] op_sel:[0,0,0] op_sel_hi:[1,1,0] neg_lo:[0,0,1] neg_hi:[0,0,1]
v_pk_fma_f32 v[18:19], v[18:19], s[92:93], v[126:127] op_sel:[0,0,0] op_sel_hi:[1,1,0] neg_lo:[0,0,1] neg_hi:[0,0,1]
v_pk_fma_f32 v[20:21], v[20:21], s[92:93], v[126:127] op_sel:[0,0,1] op_sel_hi:[1,1,1] neg_lo:[0,0,1] neg_hi:[0,0,1]
v_pk_fma_f32 v[22:23], v[22:23], s[92:93], v[126:127] op_sel:[0,0,1] op_sel_hi:[1,1,1] neg_lo:[0,0,1] neg_hi:[0,0,1]
v_exp_f32 v16, v16
v_exp_f32 v17, v17
v_exp_f32 v18, v18
v_exp_f32 v19, v19
v_exp_f32 v20, v20
v_exp_f32 v21, v21
v_exp_f32 v22, v22
v_exp_f32 v23, v23
v_cvt_pk_bf16_f32 v16, v16, v17
v_cvt_pk_bf16_f32 v18, v18, v19
v_cvt_pk_bf16_f32 v20, v20, v21
v_cvt_pk_bf16_f32 v22, v22, v23
v_rcp_f32 v204, v204
v_rcp_f32 v208, v208
v_and_b32 v92, v232, v16
v_and_b32 v93, v233, v18
v_and_b32 v94, v234, v16
v_and_b32 v95, v235, v18
v_and_b32 v96, v232, v20
v_and_b32 v97, v233, v22
v_mfma_f32_16x16x32_bf16 v[212:215], v[236:239], v[92:95], 0
v_and_b32 v98, v234, v20
v_and_b32 v99, v235, v22
v_mfma_f32_16x16x32_bf16 v[116:119], v[184:187], v[92:95], 0
v_pk_mul_f32 v[108:109], v[108:109], v[204:205] op_sel_hi:[1,0]
v_pk_mul_f32 v[110:111], v[110:111], v[204:205] op_sel_hi:[1,0]
v_mfma_f32_16x16x32_bf16 v[216:219], v[236:239], v[96:99], 0
v_pk_mul_f32 v[112:113], v[112:113], v[208:209] op_sel_hi:[1,0]
v_pk_mul_f32 v[114:115], v[114:115], v[208:209] op_sel_hi:[1,0]
v_mfma_f32_16x16x32_bf16 v[120:123], v[190:193], v[96:99], 0
v_cvt_pk_bf16_f32 v8, v108, v109
v_cvt_pk_bf16_f32 v9, v110, v111
v_mfma_f32_16x16x32_bf16 v[164:167], v[196:199], v[92:95], 0
v_cvt_pk_bf16_f32 v10, v112, v113
v_cvt_pk_bf16_f32 v11, v114, v115
v_mfma_f32_16x16x32_bf16 v[168:171], v[196:199], v[96:99], 0
buffer_store_dwordx4 v[8:11], v4, s[32:35], s94 offen offset:0 sc1
v_rcp_f32 v212, v212
v_rcp_f32 v216, v216
v_pk_mul_f32 v[116:117], v[116:117], v[212:213] op_sel_hi:[1,0]
v_pk_mul_f32 v[118:119], v[118:119], v[212:213] op_sel_hi:[1,0]
v_pk_mul_f32 v[120:121], v[120:121], v[216:217] op_sel_hi:[1,0]
v_pk_mul_f32 v[122:123], v[122:123], v[216:217] op_sel_hi:[1,0]
v_cvt_pk_bf16_f32 v12, v116, v117
v_cvt_pk_bf16_f32 v13, v118, v119
v_cvt_pk_bf16_f32 v14, v120, v121
v_cvt_pk_bf16_f32 v15, v122, v123
v_mul_f32_dpp v132, v156, v204 quad_perm:[0,1,2,3] row_mask:0x1 bank_mask:0xf
v_mul_f32_dpp v133, v157, v204 quad_perm:[0,1,2,3] row_mask:0x1 bank_mask:0xf
v_mul_f32_dpp v134, v158, v204 quad_perm:[0,1,2,3] row_mask:0x1 bank_mask:0xf
v_mul_f32_dpp v135, v159, v204 quad_perm:[0,1,2,3] row_mask:0x1 bank_mask:0xf
buffer_store_dwordx4 v[12:15], v4, s[32:35], s94 offen offset:1024 sc1
v_mul_f32_dpp v132, v160, v208 quad_perm:[0,1,2,3] row_mask:0x2 bank_mask:0xf
v_mul_f32_dpp v133, v161, v208 quad_perm:[0,1,2,3] row_mask:0x2 bank_mask:0xf
v_mul_f32_dpp v134, v162, v208 quad_perm:[0,1,2,3] row_mask:0x2 bank_mask:0xf
v_mul_f32_dpp v135, v163, v208 quad_perm:[0,1,2,3] row_mask:0x2 bank_mask:0xf
v_mul_f32_dpp v132, v164, v212 quad_perm:[0,1,2,3] row_mask:0x4 bank_mask:0xf
v_mul_f32_dpp v133, v165, v212 quad_perm:[0,1,2,3] row_mask:0x4 bank_mask:0xf
v_mul_f32_dpp v134, v166, v212 quad_perm:[0,1,2,3] row_mask:0x4 bank_mask:0xf
v_mul_f32_dpp v135, v167, v212 quad_perm:[0,1,2,3] row_mask:0x4 bank_mask:0xf
v_add3_u32 v18, v8, v9, v10
v_mul_f32_dpp v132, v168, v216 quad_perm:[0,1,2,3] row_mask:0x8 bank_mask:0xf
v_mul_f32_dpp v133, v169, v216 quad_perm:[0,1,2,3] row_mask:0x8 bank_mask:0xf
v_mul_f32_dpp v134, v170, v216 quad_perm:[0,1,2,3] row_mask:0x8 bank_mask:0xf
v_mul_f32_dpp v135, v171, v216 quad_perm:[0,1,2,3] row_mask:0x8 bank_mask:0xf
v_add3_u32 v19, v12, v13, v14
v_add3_u32 v18, v18, v11, v15
v_cvt_pk_bf16_f32 v16, v132, v133
v_cvt_pk_bf16_f32 v17, v134, v135
v_add3_u32 v18, v18, v19, v253
v_add3_u32 v18, v18, v16, v17
buffer_store_dwordx3 v[16:18], v2, s[32:35], s94 offen offset:2048 sc1
L_P2_PRE:
v_lshlrev_b32 v2, 4, v1
s_lshr_b32 s64, s22, 2
s_mul_i32 s60, s64, 24576
s_add_u32 s60, s60, 49152
v_add_u32 v248, s60, v2
s_mul_i32 s60, s64, 14336
s_add_u32 s60, s60, 98304
v_add_u32 v249, s60, v2
ds_read_b128 v[48:51], v248 offset:0
ds_read_b128 v[52:55], v248 offset:1024
ds_read_b128 v[56:59], v248 offset:2048
ds_read_b128 v[60:63], v248 offset:3072
ds_read_b128 v[64:67], v248 offset:4096
ds_read_b128 v[68:71], v248 offset:5120
ds_read_b128 v[72:75], v248 offset:6144
ds_read_b128 v[76:79], v248 offset:7168
ds_read_b128 v[80:83], v248 offset:8192
ds_read_b128 v[84:87], v248 offset:9216
ds_read_b128 v[88:91], v248 offset:10240
ds_read_b128 v[92:95], v248 offset:11264
ds_read_b128 v[96:99], v248 offset:12288
ds_read_b128 v[100:103], v248 offset:13312
ds_read_b128 v[104:107], v248 offset:14336
ds_read_b128 v[108:111], v248 offset:15360
ds_read_b128 v[112:115], v248 offset:16384
ds_read_b128 v[116:119], v248 offset:17408
ds_read_b128 v[120:123], v248 offset:18432
ds_read_b128 v[124:127], v248 offset:19456
ds_read_b128 v[128:131], v248 offset:20480
ds_read_b128 v[132:135], v248 offset:21504
ds_read_b128 v[136:139], v248 offset:22528
ds_read_b128 v[140:143], v248 offset:23552
ds_read_b128 v[144:147], v249 offset:0
ds_read_b128 v[148:151], v249 offset:1024
ds_read_b128 v[152:155], v249 offset:2048
ds_read_b128 v[156:159], v249 offset:3072
ds_read_b128 v[160:163], v249 offset:4096
ds_read_b128 v[164:167], v249 offset:5120
L_P2_PRE2:
s_mul_i32 s60, s64, 24576
s_add_u32 s60, s60, 0
v_add_u32 v250, s60, v2
s_mul_i32 s60, s64, 6144
s_add_u32 s60, s60, 151552
v_add_u32 v251, s60, v2
s_mul_i32 s60, s64, 2048
s_add_u32 s60, s60, 147456
v_add_u32 v252, s60, v2
s_bfe_u32 s84, s2, 0x30003
s_and_b32 s85, s2, 7
s_lshl_b32 s85, s85, 2
s_lshr_b32 s86, s2, 6
s_add_u32 s85, s85, s86
s_xor_b32 s86, s84, s85
s_and_b32 s86, s86, 0
s_and_b32 s65, s22, 3
s_lshl_b32 s67, s85, 2
s_add_u32 s67, s67, s65
s_mul_i32 s80, s67, 45056
s_mul_i32 s60, s64, 22528
s_add_u32 s80, s80, s60
v_mul_u32_u24 v3, 12, v1
v_add_u32 v3, 2048, v3
v_and_b32 v4, 15, v1
v_lshlrev_b32 v5, 3, v4
s_lshl_b32 s62, s67, 7
s_add_u32 s62, s62, 7405568
v_sub_u32 v254, 0, v253
s_add_u32 s82, s80, 11264
s_mul_i32 s86, s86, 11264
s_add_u32 s80, s80, s86
s_sub_u32 s82, s82, s86
s_add_u32 s81, s80, 5632
s_add_u32 s83, s82, 5632
s_mov_b32 s28, s18
s_mov_b32 s29, s19
s_mov_b32 s30, 2621440
s_mov_b32 s31, 0x20000
s_mov_b32 s61, 0
s_waitcnt lgkmcnt(0)
s_barrier
s_cmp_lt_u32 s22, 4
s_cbranch_scc1 L_P2_C
s_mul_i32 s53, s44, 24576
s_add_u32 s53, s53, s45
s_add_u32 m0, s53, 49152
s_add_u32 s51, s55, 71680
buffer_load_dwordx4 v12, s[32:35], s51 offen sc1 lds
s_add_u32 m0, s53, 51200
s_add_u32 s51, s55, 73728
buffer_load_dwordx4 v12, s[32:35], s51 offen sc1 lds
s_add_u32 m0, s53, 53248
s_add_u32 s51, s55, 75776
buffer_load_dwordx4 v12, s[32:35], s51 offen sc1 lds
s_add_u32 m0, s53, 55296
s_add_u32 s51, s55, 77824
buffer_load_dwordx4 v12, s[32:35], s51 offen sc1 lds
s_add_u32 m0, s53, 57344
s_add_u32 s51, s55, 79872
buffer_load_dwordx4 v12, s[32:35], s51 offen sc1 lds
s_add_u32 m0, s53, 59392
s_add_u32 s51, s55, 81920
buffer_load_dwordx4 v12, s[32:35], s51 offen sc1 lds
s_add_u32 m0, s53, 61440
s_add_u32 s51, s55, 83968
buffer_load_dwordx4 v12, s[32:35], s51 offen sc1 lds
s_add_u32 m0, s53, 63488
s_add_u32 s51, s55, 86016
buffer_load_dwordx4 v12, s[32:35], s51 offen sc1 lds
s_add_u32 m0, s53, 65536
s_add_u32 s51, s55, 88064
buffer_load_dwordx4 v12, s[32:35], s51 offen sc1 lds
s_add_u32 m0, s53, 67584
s_add_u32 s51, s55, 90112
buffer_load_dwordx4 v12, s[32:35], s51 offen sc1 lds
s_add_u32 m0, s53, 69632
s_add_u32 s51, s55, 92160
buffer_load_dwordx4 v12, s[32:35], s51 offen sc1 lds
s_add_u32 m0, s53, 71680
s_add_u32 s51, s55, 94208
buffer_load_dwordx4 v12, s[32:35], s51 offen sc1 lds
s_mul_i32 s53, s44, 14336
s_add_u32 s53, s53, s45
s_add_u32 m0, s53, 98304
s_add_u32 s51, s55, 96256
buffer_load_dwordx4 v12, s[32:35], s51 offen sc1 lds
s_add_u32 m0, s53, 100352
s_add_u32 s51, s55, 98304
buffer_load_dwordx4 v12, s[32:35], s51 offen sc1 lds
s_add_u32 m0, s53, 102400
s_add_u32 s51, s55, 100352
buffer_load_dwordx4 v12, s[32:35], s51 offen sc1 lds
s_setprio 0
s_waitcnt vmcnt(0)
s_branch L_P2_GO
L_P2_C:
s_waitcnt vmcnt(0)
s_setprio 0
L_P2_GO:
s_barrier
buffer_load_dwordx4 v[168:171], v2, s[32:35], s80 offen offset:0 sc1
buffer_load_dwordx4 v[172:175], v2, s[32:35], s80 offen offset:1024 sc1
buffer_load_dwordx3 v[176:178], v3, s[32:35], s80 offen offset:0 sc1
buffer_load_dwordx4 v[180:183], v2, s[32:35], s80 offen offset:2816 sc1
buffer_load_dwordx4 v[184:187], v2, s[32:35], s80 offen offset:3840 sc1
buffer_load_dwordx3 v[188:190], v3, s[32:35], s80 offen offset:2816 sc1
s_waitcnt vmcnt(3)
buffer_load_dwordx4 v[192:195], v2, s[32:35], s81 offen offset:0 sc1
buffer_load_dwordx4 v[196:199], v2, s[32:35], s81 offen offset:1024 sc1
buffer_load_dwordx3 v[200:202], v3, s[32:35], s81 offen offset:0 sc1
v_add3_u32 v244, v168, v169, v170
v_add3_u32 v245, v172, v173, v174
v_add3_u32 v246, v176, v177, v253
v_add3_u32 v244, v244, v171, v175
v_add3_u32 v244, v244, v245, v246
v_cmp_ne_u32 vcc, v244, v178
s_cbranch_vccnz L_RETRY0
L_OK0:
v_mov_b64 v[216:217], v[176:177]
v_mfma_f32_16x16x32_bf16 v[224:227], v[48:51], v[168:171], 0
v_mfma_f32_16x16x32_bf16 v[228:231], v[52:55], v[168:171], 0
v_mfma_f32_16x16x32_bf16 v[232:235], v[56:59], v[168:171], 0
v_mfma_f32_16x16x32_bf16 v[236:239], v[60:63], v[168:171], 0
v_mfma_f32_16x16x32_bf16 v[240:243], v[64:67], v[168:171], 0
v_mfma_f32_16x16x32_bf16 v[224:227], v[68:71], v[172:175], v[224:227]
v_mfma_f32_16x16x32_bf16 v[228:231], v[72:75], v[172:175], v[228:231]
v_mfma_f32_16x16x32_bf16 v[232:235], v[76:79], v[172:175], v[232:235]
v_mfma_f32_16x16x32_bf16 v[236:239], v[80:83], v[172:175], v[236:239]
v_mfma_f32_16x16x32_bf16 v[240:243], v[84:87], v[172:175], v[240:243]
s_waitcnt vmcnt(3)
buffer_load_dwordx4 v[204:207], v2, s[32:35], s81 offen offset:2816 sc1
buffer_load_dwordx4 v[208:211], v2, s[32:35], s81 offen offset:3840 sc1
buffer_load_dwordx3 v[212:214], v3, s[32:35], s81 offen offset:2816 sc1
v_add3_u32 v244, v180, v181, v182
v_add3_u32 v245, v184, v185, v186
v_add3_u32 v246, v188, v189, v253
v_add3_u32 v244, v244, v183, v187
v_add3_u32 v244, v244, v245, v246
v_cmp_ne_u32 vcc, v244, v190
s_cbranch_vccnz L_RETRY1
L_OK1:
v_mov_b64 v[218:219], v[188:189]
v_mfma_f32_16x16x32_bf16 v[224:227], v[88:91], v[180:183], v[224:227]
v_mfma_f32_16x16x32_bf16 v[228:231], v[92:95], v[180:183], v[228:231]
v_mfma_f32_16x16x32_bf16 v[232:235], v[96:99], v[180:183], v[232:235]
v_mfma_f32_16x16x32_bf16 v[236:239], v[100:103], v[180:183], v[236:239]
v_mfma_f32_16x16x32_bf16 v[240:243], v[104:107], v[180:183], v[240:243]
v_mfma_f32_16x16x32_bf16 v[224:227], v[108:111], v[184:187], v[224:227]
v_mfma_f32_16x16x32_bf16 v[228:231], v[112:115], v[184:187], v[228:231]
v_mfma_f32_16x16x32_bf16 v[232:235], v[116:119], v[184:187], v[232:235]
v_mfma_f32_16x16x32_bf16 v[236:239], v[120:123], v[184:187], v[236:239]
v_mfma_f32_16x16x32_bf16 v[240:243], v[124:127], v[184:187], v[240:243]
v_mfma_f32_16x16x32_bf16 v[224:227], v[128:131], v[216:219], v[224:227]
ds_read_b128 v[8:11], v249 offset:6144
v_mfma_f32_16x16x32_bf16 v[228:231], v[132:135], v[216:219], v[228:231]
ds_read_b128 v[12:15], v249 offset:7168
v_mfma_f32_16x16x32_bf16 v[232:235], v[136:139], v[216:219], v[232:235]
ds_read_b128 v[16:19], v249 offset:8192
v_mfma_f32_16x16x32_bf16 v[236:239], v[140:143], v[216:219], v[236:239]
ds_read_b128 v[20:23], v249 offset:9216
v_mfma_f32_16x16x32_bf16 v[240:243], v[144:147], v[216:219], v[240:243]
ds_read_b128 v[24:27], v249 offset:10240
s_waitcnt vmcnt(3)
buffer_load_dwordx4 v[168:171], v2, s[32:35], s82 offen offset:0 sc1
buffer_load_dwordx4 v[172:175], v2, s[32:35], s82 offen offset:1024 sc1
buffer_load_dwordx3 v[176:178], v3, s[32:35], s82 offen offset:0 sc1
buffer_load_dwordx2 v[6:7], v5, s[32:35], s62 offen sc1
v_add3_u32 v244, v192, v193, v194
v_add3_u32 v245, v196, v197, v198
v_add3_u32 v246, v200, v201, v253
v_add3_u32 v244, v244, v195, v199
v_add3_u32 v244, v244, v245, v246
v_cmp_ne_u32 vcc, v244, v202
s_cbranch_vccnz L_RETRY2
L_OK2:
v_mov_b64 v[220:221], v[200:201]
v_mfma_f32_16x16x32_bf16 v[224:227], v[148:151], v[192:195], v[224:227]
ds_read_b128 v[28:31], v249 offset:11264
v_mfma_f32_16x16x32_bf16 v[228:231], v[152:155], v[192:195], v[228:231]
ds_read_b128 v[32:35], v249 offset:12288
v_mfma_f32_16x16x32_bf16 v[232:235], v[156:159], v[192:195], v[232:235]
ds_read_b128 v[36:39], v249 offset:13312
v_mfma_f32_16x16x32_bf16 v[236:239], v[160:163], v[192:195], v[236:239]
ds_read_b128 v[40:43], v250 offset:0
v_mfma_f32_16x16x32_bf16 v[240:243], v[164:167], v[192:195], v[240:243]
ds_read_b128 v[44:47], v250 offset:1024
s_waitcnt lgkmcnt(5)
v_mfma_f32_16x16x32_bf16 v[224:227], v[8:11], v[196:199], v[224:227]
ds_read_b128 v[48:51], v250 offset:2048
v_mfma_f32_16x16x32_bf16 v[228:231], v[12:15], v[196:199], v[228:231]
ds_read_b128 v[52:55], v250 offset:3072
v_mfma_f32_16x16x32_bf16 v[232:235], v[16:19], v[196:199], v[232:235]
ds_read_b128 v[56:59], v250 offset:4096
v_mfma_f32_16x16x32_bf16 v[236:239], v[20:23], v[196:199], v[236:239]
ds_read_b128 v[60:63], v250 offset:5120
v_mfma_f32_16x16x32_bf16 v[240:243], v[24:27], v[196:199], v[240:243]
ds_read_b128 v[64:67], v250 offset:6144
s_waitcnt vmcnt(4)
buffer_load_dwordx4 v[180:183], v2, s[32:35], s82 offen offset:2816 sc1
buffer_load_dwordx4 v[184:187], v2, s[32:35], s82 offen offset:3840 sc1
buffer_load_dwordx3 v[188:190], v3, s[32:35], s82 offen offset:2816 sc1
v_add3_u32 v244, v204, v205, v206
v_add3_u32 v245, v208, v209, v210
v_add3_u32 v246, v212, v213, v253
v_add3_u32 v244, v244, v207, v211
v_add3_u32 v244, v244, v245, v246
v_cmp_ne_u32 vcc, v244, v214
s_cbranch_vccnz L_RETRY3
L_OK3:
v_mov_b64 v[222:223], v[212:213]
s_waitcnt lgkmcnt(5)
v_mfma_f32_16x16x32_bf16 v[224:227], v[28:31], v[204:207], v[224:227]
ds_read_b128 v[8:11], v250 offset:7168
v_mfma_f32_16x16x32_bf16 v[228:231], v[32:35], v[204:207], v[228:231]
ds_read_b128 v[12:15], v250 offset:8192
v_mfma_f32_16x16x32_bf16 v[232:235], v[36:39], v[204:207], v[232:235]
ds_read_b128 v[16:19], v250 offset:9216
v_mfma_f32_16x16x32_bf16 v[236:239], v[40:43], v[204:207], v[236:239]
ds_read_b128 v[20:23], v250 offset:10240
v_mfma_f32_16x16x32_bf16 v[240:243], v[44:47], v[204:207], v[240:243]
ds_read_b128 v[24:27], v250 offset:11264
s_waitcnt lgkmcnt(5)
v_mfma_f32_16x16x32_bf16 v[224:227], v[48:51], v[208:211], v[224:227]
ds_read_b128 v[28:31], v250 offset:12288
v_mfma_f32_16x16x32_bf16 v[228:231], v[52:55], v[208:211], v[228:231]
ds_read_b128 v[32:35], v250 offset:13312
v_mfma_f32_16x16x32_bf16 v[232:235], v[56:59], v[208:211], v[232:235]
ds_read_b128 v[36:39], v250 offset:14336
v_mfma_f32_16x16x32_bf16 v[236:239], v[60:63], v[208:211], v[236:239]
ds_read_b128 v[40:43], v250 offset:15360
v_mfma_f32_16x16x32_bf16 v[240:243], v[64:67], v[208:211], v[240:243]
ds_read_b128 v[44:47], v250 offset:16384
s_waitcnt lgkmcnt(5)
v_mfma_f32_16x16x32_bf16 v[224:227], v[8:11], v[220:223], v[224:227]
ds_read_b128 v[48:51], v250 offset:17408
v_mfma_f32_16x16x32_bf16 v[228:231], v[12:15], v[220:223], v[228:231]
ds_read_b128 v[52:55], v250 offset:18432
v_mfma_f32_16x16x32_bf16 v[232:235], v[16:19], v[220:223], v[232:235]
ds_read_b128 v[56:59], v250 offset:19456
v_mfma_f32_16x16x32_bf16 v[236:239], v[20:23], v[220:223], v[236:239]
ds_read_b128 v[60:63], v250 offset:20480
v_mfma_f32_16x16x32_bf16 v[240:243], v[24:27], v[220:223], v[240:243]
ds_read_b128 v[64:67], v250 offset:21504
s_waitcnt vmcnt(4)
buffer_load_dwordx4 v[192:195], v2, s[32:35], s83 offen offset:0 sc1
buffer_load_dwordx4 v[196:199], v2, s[32:35], s83 offen offset:1024 sc1
buffer_load_dwordx3 v[200:202], v3, s[32:35], s83 offen offset:0 sc1
v_add3_u32 v244, v168, v169, v170
v_add3_u32 v245, v172, v173, v174
v_add3_u32 v246, v176, v177, v253
v_add3_u32 v244, v244, v171, v175
v_add3_u32 v244, v244, v245, v246
v_cmp_ne_u32 vcc, v244, v178
s_cbranch_vccnz L_RETRY4
L_OK4:
v_mov_b64 v[216:217], v[176:177]
s_waitcnt lgkmcnt(5)
v_mfma_f32_16x16x32_bf16 v[224:227], v[28:31], v[168:171], v[224:227]
ds_read_b128 v[8:11], v250 offset:22528
s_lshr_b32 s46, s67, 4
v_mfma_f32_16x16x32_bf16 v[228:231], v[32:35], v[168:171], v[228:231]
ds_read_b128 v[12:15], v250 offset:23552
s_lshl_b32 s46, s46, 8
v_mfma_f32_16x16x32_bf16 v[232:235], v[36:39], v[168:171], v[232:235]
ds_read_b128 v[16:19], v251 offset:0
s_bfe_u32 s47, s67, 0x10003
v_mfma_f32_16x16x32_bf16 v[236:239], v[40:43], v[168:171], v[236:239]
ds_read_b128 v[20:23], v251 offset:1024
s_add_u32 s46, s46, s47
v_mfma_f32_16x16x32_bf16 v[240:243], v[44:47], v[168:171], v[240:243]
ds_read_b128 v[24:27], v251 offset:2048
s_and_b32 s47, s67, 7
s_waitcnt lgkmcnt(5)
v_mfma_f32_16x16x32_bf16 v[224:227], v[48:51], v[172:175], v[224:227]
ds_read_b128 v[28:31], v251 offset:3072
s_lshl_b32 s47, s47, 5
v_mfma_f32_16x16x32_bf16 v[228:231], v[52:55], v[172:175], v[228:231]
ds_read_b128 v[32:35], v251 offset:4096
s_add_u32 s46, s46, s47
v_mfma_f32_16x16x32_bf16 v[232:235], v[56:59], v[172:175], v[232:235]
ds_read_b128 v[36:39], v251 offset:5120
s_mul_i32 s46, s46, 1280
v_mfma_f32_16x16x32_bf16 v[236:239], v[60:63], v[172:175], v[236:239]
ds_read_b128 v[40:43], v252 offset:0
s_mul_i32 s47, s84, 160
v_mfma_f32_16x16x32_bf16 v[240:243], v[64:67], v[172:175], v[240:243]
ds_read_b128 v[44:47], v252 offset:1024
s_add_u32 s46, s46, s47
s_waitcnt vmcnt(3)
buffer_load_dwordx4 v[204:207], v2, s[32:35], s83 offen offset:2816 sc1
buffer_load_dwordx4 v[208:211], v2, s[32:35], s83 offen offset:3840 sc1
buffer_load_dwordx3 v[212:214], v3, s[32:35], s83 offen offset:2816 sc1
v_add3_u32 v244, v180, v181, v182
v_add3_u32 v245, v184, v185, v186
v_add3_u32 v246, v188, v189, v253
v_add3_u32 v244, v244, v183, v187
v_add3_u32 v244, v244, v245, v246
v_cmp_ne_u32 vcc, v244, v190
s_cbranch_vccnz L_RETRY5
L_OK5:
v_mov_b64 v[218:219], v[188:189]
s_waitcnt lgkmcnt(5)
v_mfma_f32_16x16x32_bf16 v[224:227], v[8:11], v[180:183], v[224:227]
ds_read_b128 v[48:51], v248 offset:0
s_mul_i32 s60, s65, 5120
v_mfma_f32_16x16x32_bf16 v[228:231], v[12:15], v[180:183], v[228:231]
ds_read_b128 v[52:55], v248 offset:1024
s_add_u32 s60, s60, 126976
v_mfma_f32_16x16x32_bf16 v[232:235], v[16:19], v[180:183], v[232:235]
ds_read_b128 v[56:59], v248 offset:2048
v_add_u32 v124, s60, v2
v_mfma_f32_16x16x32_bf16 v[236:239], v[20:23], v[180:183], v[236:239]
ds_read_b128 v[60:63], v248 offset:3072
v_lshrrev_b32 v123, 2, v1
v_mfma_f32_16x16x32_bf16 v[240:243], v[24:27], v[180:183], v[240:243]
ds_read_b128 v[64:67], v248 offset:4096
v_mul_u32_u24 v4, 2560, v123
s_waitcnt lgkmcnt(5)
v_mfma_f32_16x16x32_bf16 v[224:227], v[28:31], v[184:187], v[224:227]
ds_read_b128 v[8:11], v248 offset:5120
v_and_b32 v127, 3, v1
v_mfma_f32_16x16x32_bf16 v[228:231], v[32:35], v[184:187], v[228:231]
ds_read_b128 v[12:15], v248 offset:6144
v_lshl_add_u32 v125, v127, 4, v4
v_mfma_f32_16x16x32_bf16 v[232:235], v[36:39], v[184:187], v[232:235]
ds_read_b128 v[16:19], v248 offset:7168
v_lshl_add_u32 v126, v127, 3, v4
v_mfma_f32_16x16x32_bf16 v[236:239], v[40:43], v[184:187], v[236:239]
ds_read_b128 v[20:23], v248 offset:8192
v_lshl_add_u32 v123, v127, 4, v123
v_mfma_f32_16x16x32_bf16 v[240:243], v[44:47], v[184:187], v[240:243]
ds_read_b128 v[24:27], v248 offset:9216
v_lshlrev_b32 v123, 2, v123
s_waitcnt lgkmcnt(5)
v_mfma_f32_16x16x32_bf16 v[224:227], v[48:51], v[216:219], v[224:227]
ds_read_b128 v[28:31], v248 offset:10240
v_mfma_f32_16x16x32_bf16 v[228:231], v[52:55], v[216:219], v[228:231]
ds_read_b128 v[32:35], v248 offset:11264
v_mfma_f32_16x16x32_bf16 v[232:235], v[56:59], v[216:219], v[232:235]
ds_read_b128 v[36:39], v248 offset:12288
v_mfma_f32_16x16x32_bf16 v[236:239], v[60:63], v[216:219], v[236:239]
ds_read_b128 v[40:43], v248 offset:13312
v_mfma_f32_16x16x32_bf16 v[240:243], v[64:67], v[216:219], v[240:243]
ds_read_b128 v[44:47], v248 offset:14336
s_waitcnt vmcnt(3)
v_add3_u32 v244, v192, v193, v194
v_add3_u32 v245, v196, v197, v198
v_add3_u32 v246, v200, v201, v253
v_add3_u32 v244, v244, v195, v199
v_add3_u32 v244, v244, v245, v246
v_cmp_ne_u32 vcc, v244, v202
s_cbranch_vccnz L_RETRY6
L_OK6:
v_mov_b64 v[220:221], v[200:201]
s_waitcnt lgkmcnt(5)
v_mfma_f32_16x16x32_bf16 v[224:227], v[8:11], v[192:195], v[224:227]
ds_read_b128 v[48:51], v248 offset:15360
v_mfma_f32_16x16x32_bf16 v[228:231], v[12:15], v[192:195], v[228:231]
ds_read_b128 v[52:55], v248 offset:16384
v_mfma_f32_16x16x32_bf16 v[232:235], v[16:19], v[192:195], v[232:235]
ds_read_b128 v[56:59], v248 offset:17408
v_mfma_f32_16x16x32_bf16 v[236:239], v[20:23], v[192:195], v[236:239]
ds_read_b128 v[60:63], v248 offset:18432
v_mfma_f32_16x16x32_bf16 v[240:243], v[24:27], v[192:195], v[240:243]
ds_read_b128 v[64:67], v248 offset:19456
s_waitcnt lgkmcnt(5)
v_mfma_f32_16x16x32_bf16 v[224:227], v[28:31], v[196:199], v[224:227]
ds_read_b128 v[8:11], v248 offset:20480
v_mfma_f32_16x16x32_bf16 v[228:231], v[32:35], v[196:199], v[228:231]
ds_read_b128 v[12:15], v248 offset:21504
v_mfma_f32_16x16x32_bf16 v[232:235], v[36:39], v[196:199], v[232:235]
ds_read_b128 v[16:19], v248 offset:22528
v_mfma_f32_16x16x32_bf16 v[236:239], v[40:43], v[196:199], v[236:239]
ds_read_b128 v[20:23], v248 offset:23552
v_mfma_f32_16x16x32_bf16 v[240:243], v[44:47], v[196:199], v[240:243]
ds_read_b128 v[24:27], v249 offset:0
s_waitcnt vmcnt(0)
v_add3_u32 v244, v204, v205, v206
v_add3_u32 v245, v208, v209, v210
v_add3_u32 v246, v212, v213, v253
v_add3_u32 v244, v244, v207, v211
v_add3_u32 v244, v244, v245, v246
v_cmp_ne_u32 vcc, v244, v214
s_cbranch_vccnz L_RETRY7
L_OK7:
v_mov_b64 v[222:223], v[212:213]
s_waitcnt lgkmcnt(5)
v_mfma_f32_16x16x32_bf16 v[224:227], v[48:51], v[204:207], v[224:227]
ds_read_b128 v[28:31], v249 offset:1024
v_mfma_f32_16x16x32_bf16 v[228:231], v[52:55], v[204:207], v[228:231]
ds_read_b128 v[32:35], v249 offset:2048
v_mfma_f32_16x16x32_bf16 v[232:235], v[56:59], v[204:207], v[232:235]
ds_read_b128 v[36:39], v249 offset:3072
s_waitcnt vmcnt(0)
v_mfma_f32_16x16x32_bf16 v[236:239], v[60:63], v[204:207], v[236:239]
ds_read_b128 v[40:43], v249 offset:4096
v_add3_u32 v244, v6, v7, v254
v_mfma_f32_16x16x32_bf16 v[240:243], v[64:67], v[204:207], v[240:243]
ds_read_b128 v[44:47], v249 offset:5120
v_cmp_ne_u32 vcc, 0, v244
s_cbranch_vccnz L_RETRYG
L_OKG:
s_cmp_eq_u32 s64, 0
s_cbranch_scc1 L_EPI_A
s_waitcnt lgkmcnt(5)
s_barrier
v_mfma_f32_16x16x32_bf16 v[224:227], v[8:11], v[208:211], v[224:227]
ds_read_b128 v[72:75], v124 offset:0
v_mfma_f32_16x16x32_bf16 v[228:231], v[12:15], v[208:211], v[228:231]
ds_read_b128 v[76:79], v124 offset:1024
v_mfma_f32_16x16x32_bf16 v[232:235], v[16:19], v[208:211], v[232:235]
ds_read_b128 v[80:83], v124 offset:2048
v_mfma_f32_16x16x32_bf16 v[236:239], v[20:23], v[208:211], v[236:239]
ds_read_b128 v[84:87], v124 offset:3072
v_mfma_f32_16x16x32_bf16 v[240:243], v[24:27], v[208:211], v[240:243]
ds_read_b128 v[88:91], v124 offset:4096
s_waitcnt lgkmcnt(5)
v_mfma_f32_16x16x32_bf16 v[224:227], v[28:31], v[220:223], v[224:227]
v_sub_f32 v6, 1.0, v6
v_mfma_f32_16x16x32_bf16 v[228:231], v[32:35], v[220:223], v[228:231]
v_cvt_pk_bf16_f32 v6, v6, v6
v_mfma_f32_16x16x32_bf16 v[232:235], v[36:39], v[220:223], v[232:235]
v_and_b32 v6, 0xffff0000, v6
v_mfma_f32_16x16x32_bf16 v[236:239], v[40:43], v[220:223], v[236:239]
v_mfma_f32_16x16x32_bf16 v[240:243], v[44:47], v[220:223], v[240:243]
s_waitcnt lgkmcnt(0)
v_pk_fma_f32 v[72:73], v[224:225], v[6:7], v[72:73] op_sel_hi:[1,0,1]
v_pk_fma_f32 v[74:75], v[226:227], v[6:7], v[74:75] op_sel_hi:[1,0,1]
v_cvt_pk_bf16_f32 v168, v72, v73
v_cvt_pk_bf16_f32 v169, v74, v75
ds_bpermute_b32 v180, v123, v168
ds_bpermute_b32 v181, v123, v169
v_pk_fma_f32 v[76:77], v[228:229], v[6:7], v[76:77] op_sel_hi:[1,0,1]
v_pk_fma_f32 v[78:79], v[230:231], v[6:7], v[78:79] op_sel_hi:[1,0,1]
v_cvt_pk_bf16_f32 v170, v76, v77
v_cvt_pk_bf16_f32 v171, v78, v79
ds_bpermute_b32 v182, v123, v170
ds_bpermute_b32 v183, v123, v171
v_pk_fma_f32 v[80:81], v[232:233], v[6:7], v[80:81] op_sel_hi:[1,0,1]
v_pk_fma_f32 v[82:83], v[234:235], v[6:7], v[82:83] op_sel_hi:[1,0,1]
v_cvt_pk_bf16_f32 v172, v80, v81
v_cvt_pk_bf16_f32 v173, v82, v83
ds_bpermute_b32 v184, v123, v172
ds_bpermute_b32 v185, v123, v173
v_pk_fma_f32 v[84:85], v[236:237], v[6:7], v[84:85] op_sel_hi:[1,0,1]
v_pk_fma_f32 v[86:87], v[238:239], v[6:7], v[86:87] op_sel_hi:[1,0,1]
v_cvt_pk_bf16_f32 v174, v84, v85
v_cvt_pk_bf16_f32 v175, v86, v87
ds_bpermute_b32 v186, v123, v174
ds_bpermute_b32 v187, v123, v175
v_pk_fma_f32 v[88:89], v[240:241], v[6:7], v[88:89] op_sel_hi:[1,0,1]
v_pk_fma_f32 v[90:91], v[242:243], v[6:7], v[90:91] op_sel_hi:[1,0,1]
v_cvt_pk_bf16_f32 v176, v88, v89
v_cvt_pk_bf16_f32 v177, v90, v91
s_waitcnt lgkmcnt(4)
buffer_store_dwordx4 v[180:183], v125, s[28:31], s46 offen
ds_bpermute_b32 v188, v123, v176
ds_bpermute_b32 v189, v123, v177
s_waitcnt lgkmcnt(2)
buffer_store_dwordx4 v[184:187], v125, s[28:31], s46 offen offset:64
s_waitcnt lgkmcnt(0)
buffer_store_dwordx2 v[188:189], v126, s[28:31], s46 offen offset:128
s_branch L_FIN
L_EPI_A:
s_waitcnt lgkmcnt(5)
v_mfma_f32_16x16x32_bf16 v[224:227], v[8:11], v[208:211], v[224:227]
v_mfma_f32_16x16x32_bf16 v[228:231], v[12:15], v[208:211], v[228:231]
v_mfma_f32_16x16x32_bf16 v[232:235], v[16:19], v[208:211], v[232:235]
v_mfma_f32_16x16x32_bf16 v[236:239], v[20:23], v[208:211], v[236:239]
v_mfma_f32_16x16x32_bf16 v[240:243], v[24:27], v[208:211], v[240:243]
s_waitcnt lgkmcnt(0)
v_mfma_f32_16x16x32_bf16 v[224:227], v[28:31], v[220:223], v[224:227]
v_mfma_f32_16x16x32_bf16 v[228:231], v[32:35], v[220:223], v[228:231]
v_mfma_f32_16x16x32_bf16 v[232:235], v[36:39], v[220:223], v[232:235]
v_mfma_f32_16x16x32_bf16 v[236:239], v[40:43], v[220:223], v[236:239]
v_mfma_f32_16x16x32_bf16 v[240:243], v[44:47], v[220:223], v[240:243]
s_nop 3
v_pk_mul_f32 v[224:225], v[224:225], v[6:7] op_sel_hi:[1,0]
v_pk_mul_f32 v[226:227], v[226:227], v[6:7] op_sel_hi:[1,0]
ds_write_b128 v124, v[224:227] offset:0
v_pk_mul_f32 v[228:229], v[228:229], v[6:7] op_sel_hi:[1,0]
v_pk_mul_f32 v[230:231], v[230:231], v[6:7] op_sel_hi:[1,0]
ds_write_b128 v124, v[228:231] offset:1024
v_pk_mul_f32 v[232:233], v[232:233], v[6:7] op_sel_hi:[1,0]
v_pk_mul_f32 v[234:235], v[234:235], v[6:7] op_sel_hi:[1,0]
ds_write_b128 v124, v[232:235] offset:2048
v_pk_mul_f32 v[236:237], v[236:237], v[6:7] op_sel_hi:[1,0]
v_pk_mul_f32 v[238:239], v[238:239], v[6:7] op_sel_hi:[1,0]
ds_write_b128 v124, v[236:239] offset:3072
v_pk_mul_f32 v[240:241], v[240:241], v[6:7] op_sel_hi:[1,0]
v_pk_mul_f32 v[242:243], v[242:243], v[6:7] op_sel_hi:[1,0]
ds_write_b128 v124, v[240:243] offset:4096
s_waitcnt lgkmcnt(0)
s_barrier
L_FIN:
L_END:
s_endpgm
L_RETRY0:
s_add_u32 s61, s61, 1
s_cmp_ge_u32 s61, 131072
s_cbranch_scc1 L_OK0
s_sleep 2
buffer_load_dwordx4 v[168:171], v2, s[32:35], s80 offen offset:0 sc1
buffer_load_dwordx4 v[172:175], v2, s[32:35], s80 offen offset:1024 sc1
buffer_load_dwordx3 v[176:178], v3, s[32:35], s80 offen offset:0 sc1
s_waitcnt vmcnt(0)
v_add3_u32 v244, v168, v169, v170
v_add3_u32 v245, v172, v173, v174
v_add3_u32 v246, v176, v177, v253
v_add3_u32 v244, v244, v171, v175
v_add3_u32 v244, v244, v245, v246
v_cmp_ne_u32 vcc, v244, v178
s_cbranch_vccnz L_RETRY0
s_branch L_OK0
L_RETRY1:
s_add_u32 s61, s61, 1
s_cmp_ge_u32 s61, 131072
s_cbranch_scc1 L_OK1
s_sleep 2
buffer_load_dwordx4 v[180:183], v2, s[32:35], s80 offen offset:2816 sc1
buffer_load_dwordx4 v[184:187], v2, s[32:35], s80 offen offset:3840 sc1
buffer_load_dwordx3 v[188:190], v3, s[32:35], s80 offen offset:2816 sc1
s_waitcnt vmcnt(0)
v_add3_u32 v244, v180, v181, v182
v_add3_u32 v245, v184, v185, v186
v_add3_u32 v246, v188, v189, v253
v_add3_u32 v244, v244, v183, v187
v_add3_u32 v244, v244, v245, v246
v_cmp_ne_u32 vcc, v244, v190
s_cbranch_vccnz L_RETRY1
s_branch L_OK1
L_RETRY2:
s_add_u32 s61, s61, 1
s_cmp_ge_u32 s61, 131072
s_cbranch_scc1 L_OK2
s_sleep 2
buffer_load_dwordx4 v[192:195], v2, s[32:35], s81 offen offset:0 sc1
buffer_load_dwordx4 v[196:199], v2, s[32:35], s81 offen offset:1024 sc1
buffer_load_dwordx3 v[200:202], v3, s[32:35], s81 offen offset:0 sc1
s_waitcnt vmcnt(0)
v_add3_u32 v244, v192, v193, v194
v_add3_u32 v245, v196, v197, v198
v_add3_u32 v246, v200, v201, v253
v_add3_u32 v244, v244, v195, v199
v_add3_u32 v244, v244, v245, v246
v_cmp_ne_u32 vcc, v244, v202
s_cbranch_vccnz L_RETRY2
s_branch L_OK2
L_RETRY3:
s_add_u32 s61, s61, 1
s_cmp_ge_u32 s61, 131072
s_cbranch_scc1 L_OK3
s_sleep 2
buffer_load_dwordx4 v[204:207], v2, s[32:35], s81 offen offset:2816 sc1
buffer_load_dwordx4 v[208:211], v2, s[32:35], s81 offen offset:3840 sc1
buffer_load_dwordx3 v[212:214], v3, s[32:35], s81 offen offset:2816 sc1
s_waitcnt vmcnt(0)
v_add3_u32 v244, v204, v205, v206
v_add3_u32 v245, v208, v209, v210
v_add3_u32 v246, v212, v213, v253
v_add3_u32 v244, v244, v207, v211
v_add3_u32 v244, v244, v245, v246
v_cmp_ne_u32 vcc, v244, v214
s_cbranch_vccnz L_RETRY3
s_branch L_OK3
L_RETRY4:
s_add_u32 s61, s61, 1
s_cmp_ge_u32 s61, 131072
s_cbranch_scc1 L_OK4
s_sleep 2
buffer_load_dwordx4 v[168:171], v2, s[32:35], s82 offen offset:0 sc1
buffer_load_dwordx4 v[172:175], v2, s[32:35], s82 offen offset:1024 sc1
buffer_load_dwordx3 v[176:178], v3, s[32:35], s82 offen offset:0 sc1
s_waitcnt vmcnt(0)
v_add3_u32 v244, v168, v169, v170
v_add3_u32 v245, v172, v173, v174
v_add3_u32 v246, v176, v177, v253
v_add3_u32 v244, v244, v171, v175
v_add3_u32 v244, v244, v245, v246
v_cmp_ne_u32 vcc, v244, v178
s_cbranch_vccnz L_RETRY4
s_branch L_OK4
L_RETRY5:
s_add_u32 s61, s61, 1
s_cmp_ge_u32 s61, 131072
s_cbranch_scc1 L_OK5
s_sleep 2
buffer_load_dwordx4 v[180:183], v2, s[32:35], s82 offen offset:2816 sc1
buffer_load_dwordx4 v[184:187], v2, s[32:35], s82 offen offset:3840 sc1
buffer_load_dwordx3 v[188:190], v3, s[32:35], s82 offen offset:2816 sc1
s_waitcnt vmcnt(0)
v_add3_u32 v244, v180, v181, v182
v_add3_u32 v245, v184, v185, v186
v_add3_u32 v246, v188, v189, v253
v_add3_u32 v244, v244, v183, v187
v_add3_u32 v244, v244, v245, v246
v_cmp_ne_u32 vcc, v244, v190
s_cbranch_vccnz L_RETRY5
s_branch L_OK5
L_RETRY6:
s_add_u32 s61, s61, 1
s_cmp_ge_u32 s61, 131072
s_cbranch_scc1 L_OK6
s_sleep 2
buffer_load_dwordx4 v[192:195], v2, s[32:35], s83 offen offset:0 sc1
buffer_load_dwordx4 v[196:199], v2, s[32:35], s83 offen offset:1024 sc1
buffer_load_dwordx3 v[200:202], v3, s[32:35], s83 offen offset:0 sc1
s_waitcnt vmcnt(0)
v_add3_u32 v244, v192, v193, v194
v_add3_u32 v245, v196, v197, v198
v_add3_u32 v246, v200, v201, v253
v_add3_u32 v244, v244, v195, v199
v_add3_u32 v244, v244, v245, v246
v_cmp_ne_u32 vcc, v244, v202
s_cbranch_vccnz L_RETRY6
s_branch L_OK6
L_RETRY7:
s_add_u32 s61, s61, 1
s_cmp_ge_u32 s61, 131072
s_cbranch_scc1 L_OK7
s_sleep 2
buffer_load_dwordx4 v[204:207], v2, s[32:35], s83 offen offset:2816 sc1
buffer_load_dwordx4 v[208:211], v2, s[32:35], s83 offen offset:3840 sc1
buffer_load_dwordx3 v[212:214], v3, s[32:35], s83 offen offset:2816 sc1
s_waitcnt vmcnt(0)
v_add3_u32 v244, v204, v205, v206
v_add3_u32 v245, v208, v209, v210
v_add3_u32 v246, v212, v213, v253
v_add3_u32 v244, v244, v207, v211
v_add3_u32 v244, v244, v245, v246
v_cmp_ne_u32 vcc, v244, v214
s_cbranch_vccnz L_RETRY7
s_branch L_OK7
L_RETRYG:
s_add_u32 s61, s61, 1
s_cmp_ge_u32 s61, 131072
s_cbranch_scc1 L_OKG
s_sleep 2
buffer_load_dwordx2 v[6:7], v5, s[32:35], s62 offen sc1
s_waitcnt vmcnt(0)
v_add3_u32 v244, v6, v7, v254
v_cmp_ne_u32 vcc, 0, v244
s_cbranch_vccnz L_RETRYG
s_branch L_OKG
CODE_END:
.section .rodata,"a"
.p2align 6
.amdhsa_kernel gated_mix__sliding_local_dilated__sliding_local_dilated__prompt_kernel
  .amdhsa_next_free_vgpr 256
  .amdhsa_next_free_sgpr 102
  .amdhsa_accum_offset 256
  .amdhsa_group_segment_fixed_size 0
  .amdhsa_kernarg_size 80
  .amdhsa_user_sgpr_count 2
  .amdhsa_user_sgpr_kernarg_segment_ptr 1
  .amdhsa_system_sgpr_workgroup_id_x 1
.end_amdhsa_kernel
```
